```python
import torch

def _softmax(x, axis=-1):
    return torch.softmax(x, dim=axis)

def _gelu(x):
    return torch.nn.functional.gelu(x, approximate='tanh')

def _silu(x):
    return torch.nn.functional.silu(x)

def _sigmoid(x):
    return torch.sigmoid(x)

def _layernorm(x, axis=-1, eps=1e-05):
    m = x.mean(dim=axis, keepdim=True)
    v = x.var(dim=axis, keepdim=True, unbiased=False)
    return (x - m) / torch.sqrt(v + eps)

def _scatter_add(tgt, idx, src, axis=0):
    return tgt.clone().index_add_(axis, idx, src)

def _segment_sum(src, seg, n):
    out = torch.zeros((n,) + src.shape[1:], dtype=src.dtype)
    return out.index_add_(0, seg, src)

def _pad(x, pw):
    flat = tuple((v for pair in reversed(pw) for v in pair))
    return torch.nn.functional.pad(x, flat)
kernel_name = 'gated_mix__ssm_conv_h3__mixer_gmlp__prompt'

def setup_inputs():

    _w = lambda a: (lambda t: t.to(torch.bfloat16) if t.is_floating_point() else t)(torch.as_tensor(a))

    def _A_setup():
        B, S, D = (1, 2048, 448)
        ks = 4
        return {'q': _w((lambda *s: torch.randn(*s, dtype=torch.bfloat16) * 0.05)(B, S, D)), 'k': _w((lambda *s: torch.randn(*s, dtype=torch.bfloat16) * 1.6)(B, S, D)), 'v': _w((lambda *s: torch.randn(*s, dtype=torch.bfloat16) * 1.6)(B, S, D)), 'shift_k': _w((lambda *s: torch.randn(*s, dtype=torch.bfloat16) * 1.6)(D, ks) * 0.5), 'ssm_k': _w((lambda *s: torch.randn(*s, dtype=torch.bfloat16) * 3.2)(D, S) * (1.0 / S ** 0.5)), 'ssm_D': _w((lambda *s: torch.randn(*s, dtype=torch.bfloat16) * 1.6)(D))}
    _A_in = _A_setup()

    def _B_setup():
        B, S, D, F = (1, 2048, 448, 1792)
        Fh = F // 2
        return {'x': _w((lambda *s: torch.randn(*s, dtype=torch.bfloat16) * 0.05)(B, S, D)), 'w_in': _w((lambda *s: torch.randn(*s, dtype=torch.bfloat16) * 0.8)(D, 2 * Fh)), 'w_sp': _w(0.01 * (lambda *s: torch.randn(*s, dtype=torch.bfloat16) * 0.8)(S, S)), 'b_sp': _w(1.0 + 0.01 * (lambda *s: torch.randn(*s, dtype=torch.bfloat16) * 0.1)(S)), 'w_out': _w((lambda *s: torch.randn(*s, dtype=torch.bfloat16) * 0.1)(Fh, D))}
    _B_in = _B_setup()
    return {'A_q': _A_in['q'], 'A_k': _A_in['k'], 'A_v': _A_in['v'], 'A_shift_k': _A_in['shift_k'], 'A_ssm_k': _A_in['ssm_k'], 'A_ssm_D': _A_in['ssm_D'], 'B_x': _B_in['x'], 'B_w_in': _B_in['w_in'], 'B_w_sp': _B_in['w_sp'], 'B_b_sp': _B_in['b_sp'], 'B_w_out': _B_in['w_out'], 'gate_w': _w((lambda *s: torch.randn(*s, dtype=torch.bfloat16) * 0.05)(448) * 16.0)}

def reference(A_q, A_k, A_v, A_shift_k, A_ssm_k, A_ssm_D, B_x, B_w_in, B_w_sp, B_b_sp, B_w_out, gate_w):

    def _A_ref(q, k, v, shift_k, ssm_k, ssm_D):
        B, S, D = q.shape
        ks = shift_k.shape[-1]
        k_pad = _pad(k, ((0, 0), (ks - 1, 0), (0, 0)))
        k_shift = torch.zeros_like(k)
        for t in range(ks):
            k_shift = k_shift + k_pad[:, t:t + S, :] * shift_k[:, ks - 1 - t][None, None, :]
        kv = k_shift * v
        L = 2 * S
        kv_pad = _pad(kv, ((0, 0), (0, S), (0, 0)))
        kf_pad = _pad(ssm_k, ((0, 0), (0, S)))
        kv_f = (lambda x, axes=(-2, -1): torch.fft.rfft2(x.float(), dim=axes))(kv_pad[:, None, :, :], axes=(1, 2))
        kf_f = (lambda x, axes=(-2, -1): torch.fft.rfft2(x.float(), dim=axes))(kf_pad[:, None, :], axes=(1, 2))
        kf_f = (lambda x, *d: x.permute(*d))(kf_f, 1, 2, 0)
        y_f = kv_f * kf_f[None, :, :, :]
        y = (lambda x, s, axes=(-2, -1): torch.fft.irfft2(x, s=s, dim=axes).to(torch.bfloat16))(y_f, (1, L), axes=(1, 2))[:, 0, :S, :]
        y = y + kv * ssm_D[None, None, :]
        return q * y

    def _B_ref(x, w_in, w_sp, b_sp, w_out):
        B, S, D = x.shape
        F = w_in.shape[-1]
        Fh = F // 2
        z = _gelu(torch.einsum('bsd,df->bsf', x, w_in))
        z1 = z[..., :Fh].clone()
        z2 = _layernorm(z[..., Fh:], axis=-1)
        g = torch.einsum('ts,bsf->btf', w_sp, z2) + b_sp[None, :, None]
        return torch.einsum('bsf,fd->bsd', z1 * g, w_out)
    x = A_q
    g = _sigmoid((x * gate_w).sum(-1, keepdims=True))
    a = _A_ref(x, A_k, A_v, A_shift_k, A_ssm_k, A_ssm_D)
    b = _B_ref(x, B_w_in, B_w_sp, B_b_sp, B_w_out)
    return g * a + (1 - g) * b
```

```asm
; @launch grid=(256,1,1) block=(256,1,1) lds=163840
.amdgcn_target "amdgcn-amd-amdhsa--gfx950"
.text

.p2align 12
.globl gated_mix__ssm_conv_h3__mixer_gmlp__prompt_kernel
.p2align 8
.type gated_mix__ssm_conv_h3__mixer_gmlp__prompt_kernel,@function
gated_mix__ssm_conv_h3__mixer_gmlp__prompt_kernel:

    s_cmp_ge_u32 s2, 256
    s_cbranch_scc1 L_end
    s_load_dwordx2 s[12:13], s[0:1], 8
    s_load_dwordx2 s[16:17], s[0:1], 16
    s_load_dwordx2 s[20:21], s[0:1], 24
    s_load_dwordx2 s[8:9], s[0:1], 0
    s_load_dwordx2 s[24:25], s[0:1], 56
    s_load_dwordx2 s[36:37], s[0:1], 112
    s_load_dwordx2 s[28:29], s[0:1], 64
    s_load_dwordx2 s[48:49], s[0:1], 72
    s_load_dwordx2 s[32:33], s[0:1], 80
    s_load_dwordx2 s[44:45], s[0:1], 88
    s_load_dwordx2 s[40:41], s[0:1], 96
    s_load_dwordx2 s[52:53], s[0:1], 32
    s_load_dwordx2 s[56:57], s[0:1], 40
    v_lshrrev_b32 v2, 6, v0
    v_and_b32 v1, 63, v0
    s_getpc_b64 s[100:101]
L_pc:
    s_lshr_b32 s3, s2, 3
    v_lshl_add_u32 v3, s3, 2, v2
    v_lshl_add_u32 v3, v1, 7, v3
    v_lshlrev_b32 v3, 7, v3
    s_sub_u32 s100, s100, L_pc-gated_mix__ssm_conv_h3__mixer_gmlp__prompt_kernel
    s_subb_u32 s101, s101, 0
    v_min_u32 v3, L_codeend-gated_mix__ssm_conv_h3__mixer_gmlp__prompt_kernel-4, v3
    s_mov_b64 exec, 7
    global_load_dword v255, v3, s[100:101]
    s_mov_b64 exec, -1
    v_readfirstlane_b32 s64, v2
    s_mov_b32 s14, 1835008
    s_mov_b32 s15, 0x20000
    s_mov_b32 s18, 1835008
    s_mov_b32 s19, 0x20000
    s_mov_b32 s22, 3584
    s_mov_b32 s23, 0x20000
    s_mov_b32 s10, 1835008
    s_mov_b32 s11, 0x20000
    s_mov_b32 s26, 1605632
    s_mov_b32 s27, 0x20000
    s_mov_b32 s38, 20971520
    s_mov_b32 s39, 0x20000
    s_mov_b32 s30, 8388608
    s_mov_b32 s31, 0x20000
    s_mov_b32 s50, 4096
    s_mov_b32 s51, 0x20000
    s_mov_b32 s34, 802816
    s_mov_b32 s35, 0x20000
    s_mov_b32 s46, 896
    s_mov_b32 s47, 0x20000
    s_mov_b32 s42, 1835008
    s_mov_b32 s43, 0x20000
    s_mov_b32 s54, 1835008
    s_mov_b32 s55, 0x20000
    s_mov_b32 s58, 896
    s_mov_b32 s59, 0x20000
    s_lshr_b32 s67, s2, 3
    s_and_b32 s68, s2, 7
    s_cmp_ge_u32 s67, 28
    s_cbranch_scc1 L_helper
    s_mul_i32 s69, s67, 37
    s_lshr_b32 s69, s69, 8
    s_mul_i32 s70, s69, 7
    s_sub_u32 s63, s67, s70
    s_and_b32 s62, s68, 1
    s_lshr_b32 s68, s68, 1
    s_lshl_b32 s68, s68, 2
    s_add_u32 s60, s68, s69
    s_mul_i32 s61, s62, 7
    s_add_u32 s61, s61, s63
    s_mul_i32 s65, s64, 40960
    v_mov_b32 v2, 0
    v_lshlrev_b32 v16, 4, v1
    s_lshl_b32 s69, s69, 1
    s_add_u32 s69, s69, s63
    s_lshl_b32 s69, s69, 7
    s_sub_u32 s70, s69, 896
    s_cmp_ge_u32 s69, 896
    s_cselect_b32 s74, s70, s69
    v_lshrrev_b32 v251, 5, v1
    v_bfe_u32 v252, v1, 4, 1
    v_lshl_or_b32 v251, v252, 1, v251
    v_and_b32 v252, 7, v1
    v_xor_b32 v252, v252, v251
    v_lshlrev_b32 v252, 4, v252
    v_lshrrev_b32 v253, 3, v1
    s_lshl_b32 s3, s60, 2
    s_add_u32 s3, s3, s64
    s_mul_i32 s69, s3, 28672
    v_mul_u32_u24 v4, 896, v253
    v_add3_u32 v4, v4, v252, s69
    v_xor_b32 v5, 64, v4
    v_add_u32 v5, 6144, v5
    v_add_u32 v6, 12288, v4
    v_add_u32 v7, 12288, v5
    v_bfe_u32 v254, v1, 4, 1
    s_and_b32 s69, s64, 2
    v_or_b32 v254, s69, v254
    v_lshlrev_b32 v254, 1, v254
    v_xor_b32 v254, v254, v1
    v_and_b32 v254, 7, v254
    v_lshlrev_b32 v254, 4, v254
    s_mul_i32 s69, s64, 28672
    s_lshl_b32 s70, s61, 7
    s_add_u32 s69, s69, s70
    s_add_u32 s69, s69, 1792
    v_mul_u32_u24 v8, 3584, v253
    v_add3_u32 v8, v8, v254, s69
    v_add_u32 v9, 113664, v8
    s_add_u32 s75, s74, 128
    s_cmp_eq_u32 s75, 896
    s_cselect_b32 s75, 0, s75
    s_lshl_b32 s67, s60, 1
    s_add_u32 s67, s67, s62
    s_lshl_b32 s68, s67, 2
    s_add_u32 s68, s68, s64
    s_mul_i32 s69, s68, 14336
    s_lshl_b32 s71, s63, 7
    s_add_u32 s69, s69, s71
    v_lshrrev_b32 v248, 5, v1
    v_and_b32 v250, 31, v1
    v_mul_u32_u24 v248, 7168, v248
    v_lshl_add_u32 v248, v250, 2, v248
    v_add_u32 v248, s69, v248
    v_subrev_u32 v249, 2688, v248
    v_lshlrev_b32 v247, 2, v250
    s_lshl_b32 s70, s63, 9
    v_lshl_add_u32 v250, v250, 4, s70
    s_mov_b32 s72, 3584
    s_waitcnt lgkmcnt(0)
    buffer_load_dword v32, v249, s[12:15], 0 offen offset:0
    buffer_load_dword v33, v249, s[12:15], 0 offen offset:896
    buffer_load_dword v34, v249, s[12:15], 0 offen offset:1792
    buffer_load_dword v35, v248, s[12:15], 0 offen offset:0
    buffer_load_dword v44, v248, s[16:19], 0 offen offset:0
    buffer_load_dword v36, v248, s[12:15], 0 offen offset:896
    buffer_load_dword v45, v248, s[16:19], 0 offen offset:896
    buffer_load_dword v37, v248, s[12:15], 0 offen offset:1792
    buffer_load_dword v46, v248, s[16:19], 0 offen offset:1792
    buffer_load_dword v38, v248, s[12:15], 0 offen offset:2688
    buffer_load_dword v47, v248, s[16:19], 0 offen offset:2688
    buffer_load_dword v39, v248, s[12:15], s72 offen offset:0
    buffer_load_dword v48, v248, s[16:19], s72 offen offset:0
    buffer_load_dword v40, v248, s[12:15], s72 offen offset:896
    buffer_load_dword v49, v248, s[16:19], s72 offen offset:896
    buffer_load_dword v41, v248, s[12:15], s72 offen offset:1792
    buffer_load_dword v50, v248, s[16:19], s72 offen offset:1792
    buffer_load_dword v42, v248, s[12:15], s72 offen offset:2688
    buffer_load_dword v51, v248, s[16:19], s72 offen offset:2688
    buffer_load_dwordx4 v[52:55], v250, s[20:23], 0 offen
    buffer_load_dword v43, v247, s[56:59], s71 offen
    buffer_load_dword v3, v2, s[36:39], 0 offen sc1
    s_barrier
    s_add_u32 m0, s65, 0
    s_mul_i32 s73, s74, 1792
    buffer_load_dwordx4 v8, s[24:27], s73 offen offset:0 lds
    buffer_load_dwordx4 v9, s[24:27], s73 offen offset:1024 lds
    s_add_u32 m0, s65, 2048
    s_mul_i32 s73, s75, 1792
    buffer_load_dwordx4 v8, s[24:27], s73 offen offset:0 lds
    buffer_load_dwordx4 v9, s[24:27], s73 offen offset:1024 lds
    s_add_u32 s76, s75, 128
    s_cmp_eq_u32 s76, 896
    s_cselect_b32 s76, 0, s76
    s_add_u32 s77, s76, 128
    s_cmp_eq_u32 s77, 896
    s_cselect_b32 s77, 0, s77
    s_add_u32 s78, s77, 128
    s_cmp_eq_u32 s78, 896
    s_cselect_b32 s78, 0, s78
    s_add_u32 s79, s78, 128
    s_cmp_eq_u32 s79, 896
    s_cselect_b32 s79, 0, s79
    s_add_u32 s80, s79, 128
    s_cmp_eq_u32 s80, 896
    s_cselect_b32 s80, 0, s80
    s_lshl_b32 s69, s3, 17
    v_lshlrev_b32 v26, 12, v253
    v_add3_u32 v26, v26, v252, s69
    v_xor_b32 v27, 64, v26
    v_add_u32 v27, 31744, v27
    v_add_u32 v28, 63488, v26
    v_add_u32 v29, 63488, v27
    v_bfe_u32 v252, v1, 1, 1
    v_bfe_u32 v253, v1, 2, 1
    v_lshl_or_b32 v252, v252, 1, v253
    v_bfe_u32 v253, v1, 3, 1
    v_lshl_or_b32 v252, v253, 2, v252
    v_xor_b32 v252, v252, v251
    v_and_b32 v253, 15, v1
    v_lshlrev_b32 v253, 7, v253
    v_lshl_add_u32 v252, v252, 4, v253
    v_add_u32 v14, s65, v252
    v_xor_b32 v15, 64, v14
    v_mul_u32_u24 v251, 40960, v251
    v_bfe_u32 v252, v1, 2, 2
    v_lshl_add_u32 v251, v252, 7, v251
    v_and_b32 v252, 3, v1
    v_lshl_add_u32 v251, v252, 3, v251
    v_bfe_u32 v252, v1, 3, 2
    v_lshl_add_u32 v10, v252, 5, v251
    v_xor_b32 v11, 32, v10
    v_xor_b32 v12, 64, v10
    v_xor_b32 v13, 96, v10
    v_mov_b32 v20, 0xc0135761
    v_mov_b32 v21, 0xc0135761
    v_mov_b32 v22, 0xbdd2d3e8
    v_mov_b32 v23, 0xbdd2d3e8
    v_mov_b32 v24, 0x3f800000
    v_mov_b32 v25, 0x3f800000
    v_lshlrev_b32 v17, 2, v1
    v_subrev_u32 v240, 1792, v8
    v_subrev_u32 v241, 1792, v9
    s_lshr_b32 s70, s63, 2
    s_xor_b32 s52, s62, 1
    s_mul_i32 s52, s52, 7
    s_add_u32 s52, s52, s63
    s_lshl_b32 s69, s62, 8
    s_lshl_b32 s73, s52, 6
    s_add_u32 s73, s73, s64
    s_lshl_b32 s73, s73, 12
    s_add_u32 s73, s73, 5242880
    s_xor_b32 s71, s70, 0
    s_lshl_b32 s71, s71, 11
    s_add_u32 s81, s71, s69
    s_lshl_b32 s71, s81, 6
    s_add_u32 s93, s71, s73
    s_add_u32 s71, s63, 0
    s_and_b32 s71, s71, 3
    s_lshl_b32 s85, s71, 9
    s_add_u32 s86, s85, 128
    s_lshl_b32 s97, s71, 15
    s_xor_b32 s71, s70, 1
    s_lshl_b32 s71, s71, 11
    s_add_u32 s82, s71, s69
    s_lshl_b32 s71, s82, 6
    s_add_u32 s94, s71, s73
    s_add_u32 s71, s63, 1
    s_and_b32 s71, s71, 3
    s_lshl_b32 s87, s71, 9
    s_add_u32 s88, s87, 128
    s_lshl_b32 s98, s71, 15
    s_lshl_b32 s73, s61, 6
    s_add_u32 s73, s73, s64
    s_lshl_b32 s73, s73, 12
    s_add_u32 s73, s73, 5242880
    s_lshl_b32 s71, s81, 6
    s_add_u32 s95, s71, s73
    s_add_u32 s71, s63, 2
    s_and_b32 s71, s71, 3
    s_lshl_b32 s89, s71, 9
    s_add_u32 s90, s89, 128
    s_lshl_b32 s99, s71, 15
    s_lshl_b32 s71, s82, 6
    s_add_u32 s96, s71, s73
    s_add_u32 s71, s63, 3
    s_and_b32 s71, s71, 3
    s_lshl_b32 s91, s71, 9
    s_add_u32 s92, s91, 128
    s_lshl_b32 s100, s71, 15
    s_mul_i32 s54, s60, 14
    s_add_u32 s54, s54, s52
    s_lshl_b32 s54, s54, 2
    s_add_u32 s54, s54, s64
    s_mul_i32 s54, s54, 5120
    s_add_u32 s54, s54, 13631488
    s_add_u32 s55, s54, 4096
    s_mul_i32 s12, s60, 14
    s_add_u32 s12, s12, s61
    s_lshl_b32 s12, s12, 2
    s_add_u32 s12, s12, s64
    s_mul_i32 s12, s12, 5120
    s_add_u32 s12, s12, 13631488
    s_add_u32 s13, s12, 4096
    s_movk_i32 s53, 0xff
    s_mov_b32 s14, 0xffff0000
    v_and_b32 v253, 15, v1
    s_lshl_b32 s69, s3, 6
    v_lshl_add_u32 v208, v253, 1, s69
    v_lshl_add_u32 v221, v253, 2, s65
    s_and_b32 s69, s64, 1
    s_lshl_b32 s70, s62, 1
    s_add_u32 s69, s69, s70
    s_mul_i32 s69, s69, 40960
    v_lshl_add_u32 v222, v253, 2, s69
    v_lshrrev_b32 v253, 3, v1
    v_xor_b32 v252, v253, v1
    v_and_b32 v252, 7, v252
    v_mul_u32_u24 v254, 896, v253
    v_lshlrev_b32 v252, 4, v252
    s_lshl_b32 s69, s67, 2
    s_add_u32 s69, s69, s64
    s_mul_i32 s69, s69, 14336
    s_lshl_b32 s70, s63, 7
    s_add_u32 s69, s69, s70
    v_add3_u32 v209, v254, v252, s69
    v_add_u32 v210, 6144, v209
    v_lshrrev_b32 v251, 4, v1
    v_lshlrev_b32 v251, 1, v251
    v_xor_b32 v251, v251, v1
    v_and_b32 v251, 7, v251
    v_lshlrev_b32 v218, 4, v251
    s_mul_i32 s69, s64, 7168
    s_add_u32 s69, s69, s70
    v_add3_u32 v214, v254, v218, s69
    v_add_u32 v215, 27648, v214
    v_add_u32 v216, 55296, v214
    v_add_u32 v217, 82944, v214
    v_lshrrev_b32 v251, 5, v1
    v_and_b32 v252, 3, v1
    v_lshlrev_b32 v251, 9, v251
    v_lshl_add_u32 v251, v252, 6, v251
    v_bfe_u32 v252, v1, 2, 2
    v_lshl_add_u32 v251, v252, 4, v251
    v_bfe_u32 v252, v1, 4, 1
    v_lshl_add_u32 v211, v252, 3, v251
    v_add_u32 v213, s65, v211
    v_mov_b32 v211, v16
    v_add_u32 v212, 81920, v211
    s_lshl_b32 s16, s52, 1
    s_add_u32 s16, s16, s62
    s_mul_i32 s16, s16, 1024
    s_add_u32 s16, s16, 65536
    s_cmp_eq_u32 s64, 0
    s_cselect_b32 s16, s16, 20971520
    s_lshl_b32 s23, s61, 1
    s_add_u32 s23, s23, s62
    s_mul_i32 s23, s23, 1024
    s_add_u32 s23, s23, 65536
    s_cmp_eq_u32 s64, 0
    s_cselect_b32 s23, s23, 20971520
    v_and_b32 v219, 7, v1
    v_mul_u32_u24 v219, 128, v219
    v_add_u32 v224, 2048, v16
    s_mul_i32 s18, s3, 56
    s_lshl_b32 s70, s61, 1
    s_add_u32 s18, s18, s70
    s_lshl_b32 s18, s18, 10
    s_add_u32 s18, s18, 9437184
    s_add_u32 s19, s18, 28672
    s_lshl_b32 s70, s60, 4
    s_add_u32 s69, s70, s61
    s_mul_i32 s20, s69, 128
    s_add_u32 s20, s20, 98304
    s_cmp_eq_u32 s64, 0
    s_cselect_b32 s20, s20, 20971520
    s_mul_i32 s17, s69, 256
    s_add_u32 s17, s17, 131072
    s_cmp_eq_u32 s64, 0
    s_cselect_b32 s17, s17, 20971520
    s_mul_i32 s22, s70, 128
    s_add_u32 s22, s22, 98304
    s_cmp_eq_u32 s64, 0
    s_cselect_b32 s22, s22, 20971520
    s_mul_i32 s21, s70, 256
    s_add_u32 s21, s21, 131072
    s_cmp_eq_u32 s64, 0
    s_cselect_b32 s21, s21, 20971520
    v_min_u32 v225, 13, v1
    v_mul_u32_u24 v225, 128, v225
    v_lshlrev_b32 v226, 1, v225
    v_min_u32 v251, 9, v1
    s_mul_i32 s69, s63, 10
    v_add_u32 v251, s69, v251
    v_min_u32 v251, 63, v251
    v_and_b32 v252, 1, v251
    v_lshrrev_b32 v251, 1, v251
    v_lshlrev_b32 v251, 12, v251
    v_lshl_add_u32 v223, v252, 7, v251
    s_lshl_b32 s56, s3, 9
    s_add_u32 s56, s56, s62
    s_lshl_b32 s56, s56, 8
    s_xor_b32 s59, s60, s62
    s_and_b32 s59, s59, 1
    s_xor_b32 s57, s56, 524288
    s_xor_b32 s69, s3, 4
    s_lshl_b32 s69, s69, 17
    s_add_u32 s69, s69, s81
    s_add_u32 s69, s69, s85
    s_cmp_eq_u32 s59, 0
    s_cselect_b32 s57, s57, 0x800000
    s_cselect_b32 s58, s69, 0x800000
    v_lshrrev_b32 v251, 1, v1
    v_and_b32 v252, 1, v1
    v_lshlrev_b32 v251, 12, v251
    v_lshl_add_u32 v228, v252, 7, v251
    v_lshrrev_b32 v252, 5, v1
    v_bfe_u32 v253, v1, 4, 1
    v_lshl_or_b32 v252, v253, 1, v252
    v_lshl_add_u32 v243, v252, 4, s65
    s_mov_b64 exec, 0
    s_cmp_eq_u32 s64, 0
    s_cbranch_scc1 L_pad1
    s_cmp_eq_u32 s64, 1
    s_cbranch_scc1 L_pad2
    s_cmp_eq_u32 s64, 2
    s_cbranch_scc1 L_pad3
    s_cmp_eq_u32 s64, 3
    s_cbranch_scc1 L_pad4
L_hop1:
    s_mov_b64 exec, -1
    s_mov_b64 exec, 0
    s_cmp_eq_u32 s64, 0
    s_cbranch_scc1 L_pad5
    s_cmp_eq_u32 s64, 1
    s_cbranch_scc1 L_pad6
L_hop2:
    s_mov_b64 exec, -1
    s_waitcnt vmcnt(4)
    s_add_u32 m0, s65, 32768
    s_nop 0
    buffer_load_dwordx4 v4, s[8:11], s74 offen offset:0 lds
    buffer_load_dwordx4 v5, s[8:11], s74 offen offset:1024 lds
    buffer_load_dwordx4 v6, s[8:11], s74 offen offset:2048 lds
    buffer_load_dwordx4 v7, s[8:11], s74 offen offset:3072 lds
    v_readfirstlane_b32 s66, v3
    s_nop 0
    s_mul_i32 s66, s66, 0x9E3779B1
    s_add_u32 s66, s66, 0x7F4A7C15
    v_mov_b32 v3, s66
    s_cmp_eq_u32 s64, 0
    s_cselect_b32 s15, s66, 0
    v_lshlrev_b32 v30, 3, v1
    v_bfe_u32 v30, v3, v30, 8
    v_lshlrev_b32 v94, 16, v52
    v_lshlrev_b32 v95, 16, v54
    v_and_b32 v96, 0xffff0000, v52
    v_and_b32 v97, 0xffff0000, v54
    v_lshlrev_b32 v98, 16, v53
    v_lshlrev_b32 v99, 16, v55
    v_and_b32 v100, 0xffff0000, v53
    v_and_b32 v101, 0xffff0000, v55
    s_add_u32 m0, s65, 16384
    v_lshlrev_b32 v56, 16, v32
    v_and_b32 v57, 0xffff0000, v32
    v_lshlrev_b32 v58, 16, v33
    v_and_b32 v59, 0xffff0000, v33
    v_lshlrev_b32 v60, 16, v34
    v_and_b32 v61, 0xffff0000, v34
    v_lshlrev_b32 v62, 16, v35
    v_and_b32 v63, 0xffff0000, v35
    buffer_load_dwordx4 v4, s[8:11], s75 offen offset:0 lds
    v_lshlrev_b32 v64, 16, v36
    v_and_b32 v65, 0xffff0000, v36
    v_lshlrev_b32 v66, 16, v37
    v_and_b32 v67, 0xffff0000, v37
    v_lshlrev_b32 v68, 16, v38
    v_and_b32 v69, 0xffff0000, v38
    v_lshlrev_b32 v70, 16, v39
    v_and_b32 v71, 0xffff0000, v39
    buffer_load_dwordx4 v5, s[8:11], s75 offen offset:1024 lds
    v_lshlrev_b32 v72, 16, v40
    v_and_b32 v73, 0xffff0000, v40
    v_lshlrev_b32 v74, 16, v41
    v_and_b32 v75, 0xffff0000, v41
    v_lshlrev_b32 v76, 16, v42
    v_and_b32 v77, 0xffff0000, v42
    v_lshlrev_b32 v78, 16, v44
    v_and_b32 v79, 0xffff0000, v44
    buffer_load_dwordx4 v6, s[8:11], s75 offen offset:2048 lds
    v_lshlrev_b32 v80, 16, v45
    v_and_b32 v81, 0xffff0000, v45
    v_lshlrev_b32 v82, 16, v46
    v_and_b32 v83, 0xffff0000, v46
    v_lshlrev_b32 v84, 16, v47
    v_and_b32 v85, 0xffff0000, v47
    v_lshlrev_b32 v86, 16, v48
    v_and_b32 v87, 0xffff0000, v48
    buffer_load_dwordx4 v7, s[8:11], s75 offen offset:3072 lds
    v_lshlrev_b32 v88, 16, v49
    v_and_b32 v89, 0xffff0000, v49
    v_lshlrev_b32 v90, 16, v50
    v_and_b32 v91, 0xffff0000, v50
    v_lshlrev_b32 v92, 16, v51
    v_and_b32 v93, 0xffff0000, v51
    v_pk_mul_f32 v[102:103], v[62:63], v[94:95]
    v_pk_mul_f32 v[104:105], v[64:65], v[94:95]
    v_pk_mul_f32 v[106:107], v[66:67], v[94:95]
    v_pk_mul_f32 v[108:109], v[68:69], v[94:95]
    v_pk_mul_f32 v[110:111], v[70:71], v[94:95]
    v_pk_mul_f32 v[112:113], v[72:73], v[94:95]
    v_pk_mul_f32 v[114:115], v[74:75], v[94:95]
    v_pk_mul_f32 v[116:117], v[76:77], v[94:95]
    v_pk_fma_f32 v[102:103], v[60:61], v[96:97], v[102:103]
    v_pk_fma_f32 v[104:105], v[62:63], v[96:97], v[104:105]
    v_pk_fma_f32 v[106:107], v[64:65], v[96:97], v[106:107]
    v_pk_fma_f32 v[108:109], v[66:67], v[96:97], v[108:109]
    v_pk_fma_f32 v[110:111], v[68:69], v[96:97], v[110:111]
    v_pk_fma_f32 v[112:113], v[70:71], v[96:97], v[112:113]
    v_pk_fma_f32 v[114:115], v[72:73], v[96:97], v[114:115]
    v_pk_fma_f32 v[116:117], v[74:75], v[96:97], v[116:117]
    v_pk_fma_f32 v[102:103], v[58:59], v[98:99], v[102:103]
    v_pk_fma_f32 v[104:105], v[60:61], v[98:99], v[104:105]
    v_pk_fma_f32 v[106:107], v[62:63], v[98:99], v[106:107]
    v_pk_fma_f32 v[108:109], v[64:65], v[98:99], v[108:109]
    v_pk_fma_f32 v[110:111], v[66:67], v[98:99], v[110:111]
    v_pk_fma_f32 v[112:113], v[68:69], v[98:99], v[112:113]
    v_pk_fma_f32 v[114:115], v[70:71], v[98:99], v[114:115]
    v_pk_fma_f32 v[116:117], v[72:73], v[98:99], v[116:117]
    v_pk_fma_f32 v[102:103], v[56:57], v[100:101], v[102:103]
    v_pk_fma_f32 v[104:105], v[58:59], v[100:101], v[104:105]
    v_pk_fma_f32 v[106:107], v[60:61], v[100:101], v[106:107]
    v_pk_fma_f32 v[108:109], v[62:63], v[100:101], v[108:109]
    v_pk_fma_f32 v[110:111], v[64:65], v[100:101], v[110:111]
    v_pk_fma_f32 v[112:113], v[66:67], v[100:101], v[112:113]
    v_pk_fma_f32 v[114:115], v[68:69], v[100:101], v[114:115]
    v_pk_fma_f32 v[116:117], v[70:71], v[100:101], v[116:117]
    v_pk_mul_f32 v[102:103], v[102:103], v[78:79]
    v_pk_mul_f32 v[104:105], v[104:105], v[80:81]
    v_pk_mul_f32 v[106:107], v[106:107], v[82:83]
    v_pk_mul_f32 v[108:109], v[108:109], v[84:85]
    v_pk_mul_f32 v[110:111], v[110:111], v[86:87]
    v_pk_mul_f32 v[112:113], v[112:113], v[88:89]
    v_pk_mul_f32 v[114:115], v[114:115], v[90:91]
    v_pk_mul_f32 v[116:117], v[116:117], v[92:93]
    v_cvt_pk_bf16_f32 v120, v116, v114
    v_cvt_pk_bf16_f32 v121, v112, v110
    v_cvt_pk_bf16_f32 v122, v108, v106
    v_cvt_pk_bf16_f32 v123, v104, v102
    v_cvt_pk_bf16_f32 v124, v117, v115
    v_cvt_pk_bf16_f32 v125, v113, v111
    v_cvt_pk_bf16_f32 v126, v109, v107
    v_cvt_pk_bf16_f32 v127, v105, v103
    s_mul_i32 s69, s68, 14336
    s_lshl_b32 s70, s63, 10
    s_add_u32 s69, s69, s70
    s_add_u32 s69, s69, 1048576
    v_lshrrev_b32 v251, 5, v1
    v_mul_u32_u24 v252, 6656, v251
    v_add_u32 v252, v252, v16
    buffer_store_dwordx4 v[120:123], v252, s[36:39], s69 offen offset:0 sc1
    buffer_store_dwordx4 v[124:127], v252, s[36:39], s69 offen offset:512 sc1
    s_lshl_b32 s70, s63, 5
    s_add_u32 s68, s67, s70
    s_mul_i32 s68, s68, 128
    s_add_u32 m0, s65, 20480
    s_add_u32 s72, s68, 4096
    s_cmp_eq_u32 s64, 0
    s_cselect_b32 s72, s72, 20971520
    v_lshlrev_b32 v94, 16, v43
    buffer_load_dwordx4 v4, s[8:11], s76 offen offset:0 lds
    v_and_b32 v95, 0xffff0000, v43
    v_pk_mul_f32 v[102:103], v[102:103], v[94:95]
    v_pk_mul_f32 v[104:105], v[104:105], v[94:95]
L_pad1:
    s_cbranch_execz L_hop1
    buffer_load_dwordx4 v5, s[8:11], s76 offen offset:1024 lds
    v_pk_mul_f32 v[106:107], v[106:107], v[94:95]
    v_pk_mul_f32 v[108:109], v[108:109], v[94:95]
    v_pk_mul_f32 v[110:111], v[110:111], v[94:95]
    buffer_load_dwordx4 v6, s[8:11], s76 offen offset:2048 lds
    v_pk_mul_f32 v[112:113], v[112:113], v[94:95]
    v_pk_mul_f32 v[114:115], v[114:115], v[94:95]
    v_pk_mul_f32 v[116:117], v[116:117], v[94:95]
    buffer_load_dwordx4 v7, s[8:11], s76 offen offset:3072 lds
    v_bfe_u32 v252, v1, 3, 2
    v_mul_u32_u24 v252, 40960, v252
    v_lshl_add_u32 v252, v251, 4, v252
    s_add_u32 m0, s65, 4096
    v_and_b32 v251, 7, v1
    v_lshl_add_u32 v252, v251, 8, v252
    v_and_b32 v251, 3, v1
    s_mul_i32 s73, s76, 1792
    v_xor_b32 v251, s64, v251
    v_lshl_add_u32 v252, v251, 5, v252
    v_cvt_pk_bf16_f32 v56, v102, v104
    buffer_load_dwordx4 v8, s[24:27], s73 offen offset:0 lds
    v_cvt_pk_bf16_f32 v57, v106, v108
    v_cvt_pk_bf16_f32 v58, v110, v112
    v_cvt_pk_bf16_f32 v59, v114, v116
    buffer_load_dwordx4 v9, s[24:27], s73 offen offset:1024 lds
    ds_write_b128 v252, v[56:59] offset:36864
    v_cvt_pk_bf16_f32 v60, v103, v105
    v_cvt_pk_bf16_f32 v61, v107, v109
    v_cvt_pk_bf16_f32 v62, v111, v113
    v_cvt_pk_bf16_f32 v63, v115, v117
    ds_write_b128 v252, v[60:63] offset:36992
    v_add_u32 v251, s74, v16
    v_subrev_u32 v252, 896, v251
    v_min_u32 v251, v251, v252
    s_add_u32 m0, s65, 14336
    s_nop 0
    buffer_load_dwordx4 v251, s[44:47], 0 offen lds
    s_waitcnt vmcnt(7) lgkmcnt(0)
    s_barrier
    s_mov_b32 exec_hi, 0
    buffer_store_dword v3, v17, s[36:39], s72 offen sc1
    s_mov_b32 exec_hi, -1
    ds_read_b128 a[144:147], v14 offset:32768
    ds_read_b128 a[148:151], v14 offset:34816
    ds_read_b64_tr_b16 v[96:97], v10 offset:0
    ds_read_b64_tr_b16 v[98:99], v10 offset:512
    ds_read_b64_tr_b16 v[100:101], v11 offset:0
    ds_read_b64_tr_b16 v[102:103], v11 offset:512
    ds_read_b64_tr_b16 v[104:105], v12 offset:0
    ds_read_b64_tr_b16 v[106:107], v12 offset:512
    ds_read_b64_tr_b16 v[108:109], v13 offset:0
    ds_read_b64_tr_b16 v[110:111], v13 offset:512
    ds_read_b128 a[152:155], v15 offset:32768
    ds_read_b128 a[156:159], v15 offset:34816
    ds_read_b64_tr_b16 v[112:113], v10 offset:1024
    ds_read_b64_tr_b16 v[114:115], v10 offset:1536
    ds_read_b64_tr_b16 v[116:117], v11 offset:1024
    ds_read_b64_tr_b16 v[118:119], v11 offset:1536
    ds_read_b64_tr_b16 v[120:121], v12 offset:1024
    ds_read_b64_tr_b16 v[122:123], v12 offset:1536
    ds_read_b64_tr_b16 v[124:125], v13 offset:1024
    ds_read_b64_tr_b16 v[126:127], v13 offset:1536
    s_barrier
    s_waitcnt lgkmcnt(10)
    v_mfma_f32_16x16x32_bf16 v[32:35], v[96:99], a[144:147], 0
    ds_read_b128 a[160:163], v14 offset:16384
    ds_read_b128 a[164:167], v14 offset:18432
    s_add_u32 m0, s65, 24576
    v_mfma_f32_16x16x32_bf16 v[36:39], v[96:99], a[148:151], 0
    ds_read_b64_tr_b16 v[128:129], v10 offset:2048
    buffer_load_dwordx4 v4, s[8:11], s77 offen offset:0 lds
    v_mfma_f32_16x16x32_bf16 v[40:43], v[100:103], a[144:147], 0
    ds_read_b64_tr_b16 v[130:131], v10 offset:2560
    ds_read_b64_tr_b16 v[132:133], v11 offset:2048
    v_mfma_f32_16x16x32_bf16 v[44:47], v[100:103], a[148:151], 0
    ds_read_b64_tr_b16 v[134:135], v11 offset:2560
    v_mfma_f32_16x16x32_bf16 v[48:51], v[104:107], a[144:147], 0
    ds_read_b64_tr_b16 v[136:137], v12 offset:2048
    ds_read_b64_tr_b16 v[138:139], v12 offset:2560
    buffer_load_dwordx4 v5, s[8:11], s77 offen offset:1024 lds
    v_mfma_f32_16x16x32_bf16 v[52:55], v[104:107], a[148:151], 0
    ds_read_b64_tr_b16 v[140:141], v13 offset:2048
    v_mfma_f32_16x16x32_bf16 v[56:59], v[108:111], a[144:147], 0
    ds_read_b64_tr_b16 v[142:143], v13 offset:2560
    v_mfma_f32_16x16x32_bf16 v[60:63], v[108:111], a[148:151], 0
    ds_read_b128 a[168:171], v15 offset:16384
    ds_read_b128 a[172:175], v15 offset:18432
    buffer_load_dwordx4 v6, s[8:11], s77 offen offset:2048 lds
    s_waitcnt lgkmcnt(12)
    v_mfma_f32_16x16x32_bf16 v[32:35], v[112:115], a[152:155], v[32:35]
    ds_read_b64_tr_b16 v[144:145], v10 offset:3072
    v_mfma_f32_16x16x32_bf16 v[36:39], v[112:115], a[156:159], v[36:39]
    ds_read_b64_tr_b16 v[146:147], v10 offset:3584
    ds_read_b64_tr_b16 v[148:149], v11 offset:3072
    buffer_load_dwordx4 v7, s[8:11], s77 offen offset:3072 lds
    v_mfma_f32_16x16x32_bf16 v[40:43], v[116:119], a[152:155], v[40:43]
    ds_read_b64_tr_b16 v[150:151], v11 offset:3584
    s_add_u32 m0, s65, 6144
    v_mfma_f32_16x16x32_bf16 v[44:47], v[116:119], a[156:159], v[44:47]
    ds_read_b64_tr_b16 v[152:153], v12 offset:3072
    ds_read_b64_tr_b16 v[154:155], v12 offset:3584
    s_mul_i32 s73, s77, 1792
    v_mfma_f32_16x16x32_bf16 v[48:51], v[120:123], a[152:155], v[48:51]
    ds_read_b64_tr_b16 v[156:157], v13 offset:3072
    buffer_load_dwordx4 v8, s[24:27], s73 offen offset:0 lds
    v_mfma_f32_16x16x32_bf16 v[52:55], v[120:123], a[156:159], v[52:55]
    ds_read_b64_tr_b16 v[158:159], v13 offset:3584
    v_mfma_f32_16x16x32_bf16 v[56:59], v[124:127], a[152:155], v[56:59]
    v_mfma_f32_16x16x32_bf16 v[60:63], v[124:127], a[156:159], v[60:63]
    buffer_load_dwordx4 v9, s[24:27], s73 offen offset:1024 lds
    s_waitcnt vmcnt(8)
    s_barrier
    s_waitcnt vmcnt(7)
    ds_read_b128 v[176:179], v243 offset:14336
    ds_read_b128 v[180:183], v243 offset:14400
    ds_read_b128 v[184:187], v243 offset:14464
    ds_read_b128 v[188:191], v243 offset:14528
    s_waitcnt lgkmcnt(14)
    v_mfma_f32_16x16x32_bf16 v[32:35], v[128:131], a[160:163], v[32:35]
    ds_read_b128 a[176:179], v14 offset:20480
    ds_read_b128 a[180:183], v14 offset:22528
    v_mfma_f32_16x16x32_bf16 v[36:39], v[128:131], a[164:167], v[36:39]
    ds_read_b64_tr_b16 v[96:97], v10 offset:4096
    v_mfma_f32_16x16x32_bf16 v[40:43], v[132:135], a[160:163], v[40:43]
    ds_read_b64_tr_b16 v[98:99], v10 offset:4608
    ds_read_b64_tr_b16 v[100:101], v11 offset:4096
    s_add_u32 m0, s65, 28672
    v_mfma_f32_16x16x32_bf16 v[44:47], v[132:135], a[164:167], v[44:47]
    ds_read_b64_tr_b16 v[102:103], v11 offset:4608
    buffer_load_dwordx4 v4, s[8:11], s78 offen offset:0 lds
    v_mfma_f32_16x16x32_bf16 v[48:51], v[136:139], a[160:163], v[48:51]
    ds_read_b64_tr_b16 v[104:105], v12 offset:4096
    ds_read_b64_tr_b16 v[106:107], v12 offset:4608
    v_mfma_f32_16x16x32_bf16 v[52:55], v[136:139], a[164:167], v[52:55]
    ds_read_b64_tr_b16 v[108:109], v13 offset:4096
    v_mfma_f32_16x16x32_bf16 v[56:59], v[140:143], a[160:163], v[56:59]
    ds_read_b64_tr_b16 v[110:111], v13 offset:4608
    v_mfma_f32_16x16x32_bf16 v[60:63], v[140:143], a[164:167], v[60:63]
    ds_read_b128 a[184:187], v15 offset:20480
    ds_read_b128 a[188:191], v15 offset:22528
    buffer_load_dwordx4 v5, s[8:11], s78 offen offset:1024 lds
    s_waitcnt lgkmcnt(15)
    v_mfma_f32_16x16x32_bf16 v[32:35], v[144:147], a[168:171], v[32:35]
    ds_read_b64_tr_b16 v[112:113], v10 offset:5120
    v_mfma_f32_16x16x32_bf16 v[36:39], v[144:147], a[172:175], v[36:39]
    ds_read_b64_tr_b16 v[114:115], v10 offset:5632
    ds_read_b64_tr_b16 v[116:117], v11 offset:5120
    v_mfma_f32_16x16x32_bf16 v[40:43], v[148:151], a[168:171], v[40:43]
    ds_read_b64_tr_b16 v[118:119], v11 offset:5632
    v_mfma_f32_16x16x32_bf16 v[44:47], v[148:151], a[172:175], v[44:47]
    ds_read_b64_tr_b16 v[120:121], v12 offset:5120
    ds_read_b64_tr_b16 v[122:123], v12 offset:5632
    buffer_load_dwordx4 v6, s[8:11], s78 offen offset:2048 lds
    v_mfma_f32_16x16x32_bf16 v[48:51], v[152:155], a[168:171], v[48:51]
    ds_read_b64_tr_b16 v[124:125], v13 offset:5120
    v_mfma_f32_16x16x32_bf16 v[52:55], v[152:155], a[172:175], v[52:55]
    ds_read_b64_tr_b16 v[126:127], v13 offset:5632
    v_mfma_f32_16x16x32_bf16 v[56:59], v[156:159], a[168:171], v[56:59]
    v_mfma_f32_16x16x32_bf16 v[60:63], v[156:159], a[172:175], v[60:63]
    buffer_load_dwordx4 v7, s[8:11], s78 offen offset:3072 lds
    s_waitcnt lgkmcnt(15)
    v_mfma_f32_16x16x32_bf16 v[232:235], v[176:179], a[144:147], 0
    v_mfma_f32_16x16x32_bf16 v[236:239], v[176:179], a[148:151], 0
    s_add_u32 m0, s65, 8192
    v_mfma_f32_16x16x32_bf16 v[232:235], v[180:183], a[152:155], v[232:235]
    s_mul_i32 s73, s78, 1792
    v_mfma_f32_16x16x32_bf16 v[236:239], v[180:183], a[156:159], v[236:239]
    buffer_load_dwordx4 v8, s[24:27], s73 offen offset:0 lds
    v_mfma_f32_16x16x32_bf16 v[232:235], v[184:187], a[160:163], v[232:235]
    v_mfma_f32_16x16x32_bf16 v[236:239], v[184:187], a[164:167], v[236:239]
    v_mfma_f32_16x16x32_bf16 v[232:235], v[188:191], a[168:171], v[232:235]
    v_mfma_f32_16x16x32_bf16 v[236:239], v[188:191], a[172:175], v[236:239]
    buffer_load_dwordx4 v9, s[24:27], s73 offen offset:1024 lds
    s_waitcnt vmcnt(6)
    s_barrier
    ds_read_b128 v[192:195], v243 offset:14592
    ds_read_b128 v[196:199], v243 offset:14656
    s_waitcnt lgkmcnt(12)
    v_mfma_f32_16x16x32_bf16 v[32:35], v[96:99], a[176:179], v[32:35]
    ds_read_b128 a[192:195], v14 offset:24576
    ds_read_b128 a[196:199], v14 offset:26624
    v_mfma_f32_16x16x32_bf16 v[36:39], v[96:99], a[180:183], v[36:39]
    ds_read_b64_tr_b16 v[128:129], v10 offset:6144
    s_add_u32 m0, s65, 32768
    v_mfma_f32_16x16x32_bf16 v[40:43], v[100:103], a[176:179], v[40:43]
    ds_read_b64_tr_b16 v[130:131], v10 offset:6656
    ds_read_b64_tr_b16 v[132:133], v11 offset:6144
    buffer_load_dwordx4 v4, s[8:11], s79 offen offset:0 lds
    v_mfma_f32_16x16x32_bf16 v[44:47], v[100:103], a[180:183], v[44:47]
    ds_read_b64_tr_b16 v[134:135], v11 offset:6656
    v_mfma_f32_16x16x32_bf16 v[48:51], v[104:107], a[176:179], v[48:51]
    ds_read_b64_tr_b16 v[136:137], v12 offset:6144
    ds_read_b64_tr_b16 v[138:139], v12 offset:6656
    v_mfma_f32_16x16x32_bf16 v[52:55], v[104:107], a[180:183], v[52:55]
    ds_read_b64_tr_b16 v[140:141], v13 offset:6144
    buffer_load_dwordx4 v5, s[8:11], s79 offen offset:1024 lds
    v_mfma_f32_16x16x32_bf16 v[56:59], v[108:111], a[176:179], v[56:59]
    ds_read_b64_tr_b16 v[142:143], v13 offset:6656
    v_mfma_f32_16x16x32_bf16 v[60:63], v[108:111], a[180:183], v[60:63]
    ds_read_b128 a[200:203], v15 offset:24576
    ds_read_b128 a[204:207], v15 offset:26624
    s_waitcnt lgkmcnt(14)
    v_mfma_f32_16x16x32_bf16 v[32:35], v[112:115], a[184:187], v[32:35]
    ds_read_b64_tr_b16 v[144:145], v10 offset:7168
    v_mfma_f32_16x16x32_bf16 v[36:39], v[112:115], a[188:191], v[36:39]
    ds_read_b64_tr_b16 v[146:147], v10 offset:7680
    ds_read_b64_tr_b16 v[148:149], v11 offset:7168
    buffer_load_dwordx4 v6, s[8:11], s79 offen offset:2048 lds
    v_mfma_f32_16x16x32_bf16 v[40:43], v[116:119], a[184:187], v[40:43]
    ds_read_b64_tr_b16 v[150:151], v11 offset:7680
    v_mfma_f32_16x16x32_bf16 v[44:47], v[116:119], a[188:191], v[44:47]
    ds_read_b64_tr_b16 v[152:153], v12 offset:7168
    ds_read_b64_tr_b16 v[154:155], v12 offset:7680
    v_mfma_f32_16x16x32_bf16 v[48:51], v[120:123], a[184:187], v[48:51]
    ds_read_b64_tr_b16 v[156:157], v13 offset:7168
    buffer_load_dwordx4 v7, s[8:11], s79 offen offset:3072 lds
    v_mfma_f32_16x16x32_bf16 v[52:55], v[120:123], a[188:191], v[52:55]
    ds_read_b64_tr_b16 v[158:159], v13 offset:7680
    s_add_u32 m0, s65, 10240
    v_mfma_f32_16x16x32_bf16 v[56:59], v[124:127], a[184:187], v[56:59]
    s_mul_i32 s73, s79, 1792
    v_mfma_f32_16x16x32_bf16 v[60:63], v[124:127], a[188:191], v[60:63]
    buffer_load_dwordx4 v8, s[24:27], s73 offen offset:0 lds
    s_waitcnt lgkmcnt(15)
    v_mfma_f32_16x16x32_bf16 v[232:235], v[192:195], a[176:179], v[232:235]
    v_mfma_f32_16x16x32_bf16 v[236:239], v[192:195], a[180:183], v[236:239]
    v_mfma_f32_16x16x32_bf16 v[232:235], v[196:199], a[184:187], v[232:235]
    v_mfma_f32_16x16x32_bf16 v[236:239], v[196:199], a[188:191], v[236:239]
    buffer_load_dwordx4 v9, s[24:27], s73 offen offset:1024 lds
    s_waitcnt vmcnt(6)
    s_barrier
    s_waitcnt lgkmcnt(10)
    v_mfma_f32_16x16x32_bf16 v[32:35], v[128:131], a[192:195], v[32:35]
    ds_read_b128 a[208:211], v14 offset:28672
    ds_read_b128 a[212:215], v14 offset:30720
    s_add_u32 m0, s65, 16384
    v_mfma_f32_16x16x32_bf16 v[36:39], v[128:131], a[196:199], v[36:39]
    ds_read_b64_tr_b16 v[96:97], v10 offset:8192
    buffer_load_dwordx4 v4, s[8:11], s80 offen offset:0 lds
    v_mfma_f32_16x16x32_bf16 v[40:43], v[132:135], a[192:195], v[40:43]
    ds_read_b64_tr_b16 v[98:99], v10 offset:8704
    ds_read_b64_tr_b16 v[100:101], v11 offset:8192
    v_mfma_f32_16x16x32_bf16 v[44:47], v[132:135], a[196:199], v[44:47]
    ds_read_b64_tr_b16 v[102:103], v11 offset:8704
    v_mfma_f32_16x16x32_bf16 v[48:51], v[136:139], a[192:195], v[48:51]
    ds_read_b64_tr_b16 v[104:105], v12 offset:8192
    ds_read_b64_tr_b16 v[106:107], v12 offset:8704
    buffer_load_dwordx4 v5, s[8:11], s80 offen offset:1024 lds
    v_mfma_f32_16x16x32_bf16 v[52:55], v[136:139], a[196:199], v[52:55]
    ds_read_b64_tr_b16 v[108:109], v13 offset:8192
    v_mfma_f32_16x16x32_bf16 v[56:59], v[140:143], a[192:195], v[56:59]
    ds_read_b64_tr_b16 v[110:111], v13 offset:8704
    v_mfma_f32_16x16x32_bf16 v[60:63], v[140:143], a[196:199], v[60:63]
    ds_read_b128 a[216:219], v15 offset:28672
    ds_read_b128 a[220:223], v15 offset:30720
    buffer_load_dwordx4 v6, s[8:11], s80 offen offset:2048 lds
    s_waitcnt lgkmcnt(12)
    v_mfma_f32_16x16x32_bf16 v[32:35], v[144:147], a[200:203], v[32:35]
    ds_read_b64_tr_b16 v[112:113], v10 offset:9216
    v_mfma_f32_16x16x32_bf16 v[36:39], v[144:147], a[204:207], v[36:39]
    ds_read_b64_tr_b16 v[114:115], v10 offset:9728
    ds_read_b64_tr_b16 v[116:117], v11 offset:9216
    buffer_load_dwordx4 v7, s[8:11], s80 offen offset:3072 lds
    v_mfma_f32_16x16x32_bf16 v[40:43], v[148:151], a[200:203], v[40:43]
    ds_read_b64_tr_b16 v[118:119], v11 offset:9728
    s_add_u32 m0, s65, 12288
    v_mfma_f32_16x16x32_bf16 v[44:47], v[148:151], a[204:207], v[44:47]
    ds_read_b64_tr_b16 v[120:121], v12 offset:9216
    ds_read_b64_tr_b16 v[122:123], v12 offset:9728
    s_mul_i32 s73, s80, 1792
    v_mfma_f32_16x16x32_bf16 v[48:51], v[152:155], a[200:203], v[48:51]
    ds_read_b64_tr_b16 v[124:125], v13 offset:9216
    buffer_load_dwordx4 v8, s[24:27], s73 offen offset:0 lds
    v_mfma_f32_16x16x32_bf16 v[52:55], v[152:155], a[204:207], v[52:55]
    ds_read_b64_tr_b16 v[126:127], v13 offset:9728
    v_mfma_f32_16x16x32_bf16 v[56:59], v[156:159], a[200:203], v[56:59]
    v_mfma_f32_16x16x32_bf16 v[60:63], v[156:159], a[204:207], v[60:63]
    buffer_load_dwordx4 v9, s[24:27], s73 offen offset:1024 lds
    s_waitcnt vmcnt(6)
    s_barrier
    s_waitcnt lgkmcnt(10)
    v_mfma_f32_16x16x32_bf16 v[32:35], v[96:99], a[208:211], v[32:35]
    ds_read_b128 a[224:227], v14 offset:32768
    ds_read_b128 a[228:231], v14 offset:34816
    v_mfma_f32_16x16x32_bf16 v[36:39], v[96:99], a[212:215], v[36:39]
    ds_read_b64_tr_b16 v[128:129], v10 offset:10240
    s_add_u32 m0, s65, 20480
    v_mfma_f32_16x16x32_bf16 v[40:43], v[100:103], a[208:211], v[40:43]
    ds_read_b64_tr_b16 v[130:131], v10 offset:10752
    ds_read_b64_tr_b16 v[132:133], v11 offset:10240
    s_add_u32 s73, s81, s85
    v_mfma_f32_16x16x32_bf16 v[44:47], v[100:103], a[212:215], v[44:47]
    ds_read_b64_tr_b16 v[134:135], v11 offset:10752
    buffer_load_dwordx4 v26, s[28:31], s73 offen offset:0 lds
    v_mfma_f32_16x16x32_bf16 v[48:51], v[104:107], a[208:211], v[48:51]
    ds_read_b64_tr_b16 v[136:137], v12 offset:10240
    ds_read_b64_tr_b16 v[138:139], v12 offset:10752
    v_mfma_f32_16x16x32_bf16 v[52:55], v[104:107], a[212:215], v[52:55]
    ds_read_b64_tr_b16 v[140:141], v13 offset:10240
    v_mfma_f32_16x16x32_bf16 v[56:59], v[108:111], a[208:211], v[56:59]
    ds_read_b64_tr_b16 v[142:143], v13 offset:10752
    v_mfma_f32_16x16x32_bf16 v[60:63], v[108:111], a[212:215], v[60:63]
    ds_read_b128 a[232:235], v15 offset:32768
    ds_read_b128 a[236:239], v15 offset:34816
    buffer_load_dwordx4 v27, s[28:31], s73 offen offset:1024 lds
    s_waitcnt lgkmcnt(12)
    v_mfma_f32_16x16x32_bf16 v[32:35], v[112:115], a[216:219], v[32:35]
    ds_read_b64_tr_b16 v[144:145], v10 offset:11264
    v_mfma_f32_16x16x32_bf16 v[36:39], v[112:115], a[220:223], v[36:39]
    ds_read_b64_tr_b16 v[146:147], v10 offset:11776
    ds_read_b64_tr_b16 v[148:149], v11 offset:11264
    v_mfma_f32_16x16x32_bf16 v[40:43], v[116:119], a[216:219], v[40:43]
    ds_read_b64_tr_b16 v[150:151], v11 offset:11776
    v_mfma_f32_16x16x32_bf16 v[44:47], v[116:119], a[220:223], v[44:47]
    ds_read_b64_tr_b16 v[152:153], v12 offset:11264
    ds_read_b64_tr_b16 v[154:155], v12 offset:11776
    buffer_load_dwordx4 v28, s[28:31], s73 offen offset:2048 lds
    v_mfma_f32_16x16x32_bf16 v[48:51], v[120:123], a[216:219], v[48:51]
    ds_read_b64_tr_b16 v[156:157], v13 offset:11264
    v_mfma_f32_16x16x32_bf16 v[52:55], v[120:123], a[220:223], v[52:55]
    ds_read_b64_tr_b16 v[158:159], v13 offset:11776
    v_mfma_f32_16x16x32_bf16 v[56:59], v[124:127], a[216:219], v[56:59]
    v_mfma_f32_16x16x32_bf16 v[60:63], v[124:127], a[220:223], v[60:63]
    buffer_load_dwordx4 v29, s[28:31], s73 offen offset:3072 lds
    s_waitcnt vmcnt(4)
    s_barrier
    s_waitcnt lgkmcnt(10)
    v_mfma_f32_16x16x32_bf16 v[32:35], v[128:131], a[224:227], v[32:35]
    ds_read_b128 a[240:243], v14 offset:16384
    ds_read_b128 a[244:247], v14 offset:18432
    v_mfma_f32_16x16x32_bf16 v[36:39], v[128:131], a[228:231], v[36:39]
    ds_read_b64_tr_b16 v[96:97], v10 offset:12288
    v_mfma_f32_16x16x32_bf16 v[40:43], v[132:135], a[224:227], v[40:43]
    ds_read_b64_tr_b16 v[98:99], v10 offset:12800
    ds_read_b64_tr_b16 v[100:101], v11 offset:12288
    s_add_u32 m0, s65, 24576
    v_mfma_f32_16x16x32_bf16 v[44:47], v[132:135], a[228:231], v[44:47]
    ds_read_b64_tr_b16 v[102:103], v11 offset:12800
    s_add_u32 s73, s81, s86
    v_mfma_f32_16x16x32_bf16 v[48:51], v[136:139], a[224:227], v[48:51]
    ds_read_b64_tr_b16 v[104:105], v12 offset:12288
    ds_read_b64_tr_b16 v[106:107], v12 offset:12800
    buffer_load_dwordx4 v26, s[28:31], s73 offen offset:0 lds
    v_mfma_f32_16x16x32_bf16 v[52:55], v[136:139], a[228:231], v[52:55]
    ds_read_b64_tr_b16 v[108:109], v13 offset:12288
    v_mfma_f32_16x16x32_bf16 v[56:59], v[140:143], a[224:227], v[56:59]
    ds_read_b64_tr_b16 v[110:111], v13 offset:12800
    v_mfma_f32_16x16x32_bf16 v[60:63], v[140:143], a[228:231], v[60:63]
    ds_read_b128 a[248:251], v15 offset:16384
    ds_read_b128 a[252:255], v15 offset:18432
    s_waitcnt lgkmcnt(12)
    v_mfma_f32_16x16x32_bf16 v[32:35], v[144:147], a[232:235], v[32:35]
    ds_read_b64_tr_b16 v[112:113], v10 offset:13312
    v_mfma_f32_16x16x32_bf16 v[36:39], v[144:147], a[236:239], v[36:39]
    ds_read_b64_tr_b16 v[114:115], v10 offset:13824
    ds_read_b64_tr_b16 v[116:117], v11 offset:13312
    buffer_load_dwordx4 v27, s[28:31], s73 offen offset:1024 lds
    v_mfma_f32_16x16x32_bf16 v[40:43], v[148:151], a[232:235], v[40:43]
    ds_read_b64_tr_b16 v[118:119], v11 offset:13824
    v_mfma_f32_16x16x32_bf16 v[44:47], v[148:151], a[236:239], v[44:47]
    ds_read_b64_tr_b16 v[120:121], v12 offset:13312
    ds_read_b64_tr_b16 v[122:123], v12 offset:13824
    v_mfma_f32_16x16x32_bf16 v[48:51], v[152:155], a[232:235], v[48:51]
    ds_read_b64_tr_b16 v[124:125], v13 offset:13312
    v_mfma_f32_16x16x32_bf16 v[52:55], v[152:155], a[236:239], v[52:55]
    ds_read_b64_tr_b16 v[126:127], v13 offset:13824
    v_mfma_f32_16x16x32_bf16 v[56:59], v[156:159], a[232:235], v[56:59]
    v_mfma_f32_16x16x32_bf16 v[60:63], v[156:159], a[236:239], v[60:63]
    buffer_load_dwordx4 v28, s[28:31], s73 offen offset:2048 lds
    s_waitcnt lgkmcnt(10)
    v_mfma_f32_16x16x32_bf16 v[32:35], v[96:99], a[240:243], v[32:35]
    v_mfma_f32_16x16x32_bf16 v[36:39], v[96:99], a[244:247], v[36:39]
    v_mfma_f32_16x16x32_bf16 v[40:43], v[100:103], a[240:243], v[40:43]
    v_mfma_f32_16x16x32_bf16 v[44:47], v[100:103], a[244:247], v[44:47]
    v_mfma_f32_16x16x32_bf16 v[48:51], v[104:107], a[240:243], v[48:51]
    v_mfma_f32_16x16x32_bf16 v[52:55], v[104:107], a[244:247], v[52:55]
    v_mfma_f32_16x16x32_bf16 v[56:59], v[108:111], a[240:243], v[56:59]
    v_mfma_f32_16x16x32_bf16 v[60:63], v[108:111], a[244:247], v[60:63]
    buffer_load_dwordx4 v29, s[28:31], s73 offen offset:3072 lds
    s_waitcnt lgkmcnt(0)
    v_mfma_f32_16x16x32_bf16 v[32:35], v[112:115], a[248:251], v[32:35]
    v_mfma_f32_16x16x32_bf16 v[36:39], v[112:115], a[252:255], v[36:39]
    v_mfma_f32_16x16x32_bf16 v[40:43], v[116:119], a[248:251], v[40:43]
    v_mfma_f32_16x16x32_bf16 v[44:47], v[116:119], a[252:255], v[44:47]
    v_mfma_f32_16x16x32_bf16 v[48:51], v[120:123], a[248:251], v[48:51]
    v_mfma_f32_16x16x32_bf16 v[52:55], v[120:123], a[252:255], v[52:55]
    v_mfma_f32_16x16x32_bf16 v[56:59], v[124:127], a[248:251], v[56:59]
    v_mfma_f32_16x16x32_bf16 v[60:63], v[124:127], a[252:255], v[60:63]
    buffer_load_dword v242, v223, s[28:31], s56 offen offset:3584
    v_pk_mul_f32 v[248:249], v[32:33], v[32:33]
    v_pk_fma_f32 v[248:249], v[248:249], v[22:23], v[20:21]
    v_pk_mul_f32 v[248:249], v[248:249], v[32:33]
    v_exp_f32 v248, v248
    v_pk_mul_f32 v[250:251], v[34:35], v[34:35]
    v_pk_fma_f32 v[250:251], v[250:251], v[22:23], v[20:21]
    v_exp_f32 v249, v249
    v_pk_mul_f32 v[250:251], v[250:251], v[34:35]
    v_exp_f32 v250, v250
    v_pk_mul_f32 v[252:253], v[36:37], v[36:37]
    v_pk_fma_f32 v[252:253], v[252:253], v[22:23], v[20:21]
    v_exp_f32 v251, v251
    v_pk_mul_f32 v[252:253], v[252:253], v[36:37]
    v_exp_f32 v252, v252
    v_pk_mul_f32 v[254:255], v[38:39], v[38:39]
    v_pk_fma_f32 v[254:255], v[254:255], v[22:23], v[20:21]
    v_exp_f32 v253, v253
    v_pk_mul_f32 v[254:255], v[254:255], v[38:39]
    v_exp_f32 v254, v254
    v_pk_add_f32 v[248:249], v[248:249], v[24:25]
    v_pk_add_f32 v[250:251], v[250:251], v[24:25]
    v_exp_f32 v255, v255
    v_pk_add_f32 v[252:253], v[252:253], v[24:25]
    v_rcp_f32 v248, v248
    v_pk_add_f32 v[254:255], v[254:255], v[24:25]
    v_rcp_f32 v249, v249
    v_rcp_f32 v250, v250
    v_pk_mul_f32 v[32:33], v[32:33], v[248:249]
    v_rcp_f32 v251, v251
    v_rcp_f32 v252, v252
    v_pk_mul_f32 v[34:35], v[34:35], v[250:251]
    v_rcp_f32 v253, v253
    v_rcp_f32 v254, v254
    v_pk_mul_f32 v[36:37], v[36:37], v[252:253]
    v_rcp_f32 v255, v255
    s_nop 0
    v_pk_mul_f32 v[38:39], v[38:39], v[254:255]
    v_pk_mul_f32 v[248:249], v[40:41], v[40:41]
    v_pk_fma_f32 v[248:249], v[248:249], v[22:23], v[20:21]
    v_pk_mul_f32 v[248:249], v[248:249], v[40:41]
    v_exp_f32 v248, v248
    v_pk_mul_f32 v[250:251], v[42:43], v[42:43]
    v_pk_fma_f32 v[250:251], v[250:251], v[22:23], v[20:21]
    v_exp_f32 v249, v249
    v_pk_mul_f32 v[250:251], v[250:251], v[42:43]
    v_exp_f32 v250, v250
    v_pk_mul_f32 v[252:253], v[44:45], v[44:45]
    v_pk_fma_f32 v[252:253], v[252:253], v[22:23], v[20:21]
    v_exp_f32 v251, v251
    v_pk_mul_f32 v[252:253], v[252:253], v[44:45]
    v_exp_f32 v252, v252
    v_pk_mul_f32 v[254:255], v[46:47], v[46:47]
    v_pk_fma_f32 v[254:255], v[254:255], v[22:23], v[20:21]
    v_exp_f32 v253, v253
    v_pk_mul_f32 v[254:255], v[254:255], v[46:47]
    v_exp_f32 v254, v254
    v_pk_add_f32 v[248:249], v[248:249], v[24:25]
    v_pk_add_f32 v[250:251], v[250:251], v[24:25]
    v_exp_f32 v255, v255
    v_pk_add_f32 v[252:253], v[252:253], v[24:25]
    v_rcp_f32 v248, v248
    v_pk_add_f32 v[254:255], v[254:255], v[24:25]
    v_rcp_f32 v249, v249
    v_rcp_f32 v250, v250
    v_pk_mul_f32 v[40:41], v[40:41], v[248:249]
    v_rcp_f32 v251, v251
    v_rcp_f32 v252, v252
    v_pk_mul_f32 v[42:43], v[42:43], v[250:251]
    v_rcp_f32 v253, v253
    v_rcp_f32 v254, v254
    v_pk_mul_f32 v[44:45], v[44:45], v[252:253]
    v_rcp_f32 v255, v255
    s_nop 0
    v_pk_mul_f32 v[46:47], v[46:47], v[254:255]
    v_pk_mul_f32 v[248:249], v[48:49], v[48:49]
    v_pk_fma_f32 v[248:249], v[248:249], v[22:23], v[20:21]
    v_pk_mul_f32 v[248:249], v[248:249], v[48:49]
    v_exp_f32 v248, v248
    v_pk_mul_f32 v[250:251], v[50:51], v[50:51]
    v_pk_fma_f32 v[250:251], v[250:251], v[22:23], v[20:21]
    v_exp_f32 v249, v249
    v_pk_mul_f32 v[250:251], v[250:251], v[50:51]
    v_exp_f32 v250, v250
    v_pk_mul_f32 v[252:253], v[52:53], v[52:53]
    v_pk_fma_f32 v[252:253], v[252:253], v[22:23], v[20:21]
    v_exp_f32 v251, v251
    v_pk_mul_f32 v[252:253], v[252:253], v[52:53]
    v_exp_f32 v252, v252
    v_pk_mul_f32 v[254:255], v[54:55], v[54:55]
    v_pk_fma_f32 v[254:255], v[254:255], v[22:23], v[20:21]
    v_exp_f32 v253, v253
    v_pk_mul_f32 v[254:255], v[254:255], v[54:55]
    v_exp_f32 v254, v254
    v_pk_add_f32 v[248:249], v[248:249], v[24:25]
    v_pk_add_f32 v[250:251], v[250:251], v[24:25]
    v_exp_f32 v255, v255
    v_pk_add_f32 v[252:253], v[252:253], v[24:25]
    v_rcp_f32 v248, v248
    v_pk_add_f32 v[254:255], v[254:255], v[24:25]
    v_rcp_f32 v249, v249
    v_rcp_f32 v250, v250
    v_pk_mul_f32 v[48:49], v[48:49], v[248:249]
    v_rcp_f32 v251, v251
    v_rcp_f32 v252, v252
    v_pk_mul_f32 v[50:51], v[50:51], v[250:251]
    v_rcp_f32 v253, v253
    v_rcp_f32 v254, v254
    v_pk_mul_f32 v[52:53], v[52:53], v[252:253]
    v_rcp_f32 v255, v255
    s_nop 0
    v_pk_mul_f32 v[54:55], v[54:55], v[254:255]
    v_pk_mul_f32 v[248:249], v[56:57], v[56:57]
    v_pk_fma_f32 v[248:249], v[248:249], v[22:23], v[20:21]
    v_pk_mul_f32 v[248:249], v[248:249], v[56:57]
    v_exp_f32 v248, v248
    v_pk_mul_f32 v[250:251], v[58:59], v[58:59]
    v_pk_fma_f32 v[250:251], v[250:251], v[22:23], v[20:21]
    v_exp_f32 v249, v249
    v_pk_mul_f32 v[250:251], v[250:251], v[58:59]
    v_exp_f32 v250, v250
    v_pk_mul_f32 v[252:253], v[60:61], v[60:61]
    v_pk_fma_f32 v[252:253], v[252:253], v[22:23], v[20:21]
    v_exp_f32 v251, v251
    v_pk_mul_f32 v[252:253], v[252:253], v[60:61]
    v_exp_f32 v252, v252
    v_pk_mul_f32 v[254:255], v[62:63], v[62:63]
    v_pk_fma_f32 v[254:255], v[254:255], v[22:23], v[20:21]
    v_exp_f32 v253, v253
    v_pk_mul_f32 v[254:255], v[254:255], v[62:63]
    v_exp_f32 v254, v254
    v_pk_add_f32 v[248:249], v[248:249], v[24:25]
    v_pk_add_f32 v[250:251], v[250:251], v[24:25]
    v_exp_f32 v255, v255
    v_pk_add_f32 v[252:253], v[252:253], v[24:25]
    v_rcp_f32 v248, v248
    v_pk_add_f32 v[254:255], v[254:255], v[24:25]
    v_rcp_f32 v249, v249
    v_rcp_f32 v250, v250
    v_pk_mul_f32 v[56:57], v[56:57], v[248:249]
    v_rcp_f32 v251, v251
    v_rcp_f32 v252, v252
    v_pk_mul_f32 v[58:59], v[58:59], v[250:251]
    v_rcp_f32 v253, v253
    v_rcp_f32 v254, v254
    v_pk_mul_f32 v[60:61], v[60:61], v[252:253]
    v_rcp_f32 v255, v255
    s_nop 0
    v_pk_mul_f32 v[62:63], v[62:63], v[254:255]
    v_pk_mul_f32 v[98:99], v[32:33], v[32:33]
    v_pk_add_f32 v[96:97], v[34:35], v[32:33]
    v_pk_fma_f32 v[98:99], v[34:35], v[34:35], v[98:99]
    v_pk_add_f32 v[96:97], v[40:41], v[96:97]
    v_pk_fma_f32 v[98:99], v[40:41], v[40:41], v[98:99]
    v_pk_add_f32 v[96:97], v[42:43], v[96:97]
    v_pk_fma_f32 v[98:99], v[42:43], v[42:43], v[98:99]
    v_pk_add_f32 v[96:97], v[48:49], v[96:97]
    v_pk_fma_f32 v[98:99], v[48:49], v[48:49], v[98:99]
    v_pk_add_f32 v[96:97], v[50:51], v[96:97]
    v_pk_fma_f32 v[98:99], v[50:51], v[50:51], v[98:99]
    v_pk_add_f32 v[96:97], v[56:57], v[96:97]
    v_pk_fma_f32 v[98:99], v[56:57], v[56:57], v[98:99]
    v_pk_add_f32 v[96:97], v[58:59], v[96:97]
    v_pk_fma_f32 v[98:99], v[58:59], v[58:59], v[98:99]
    v_pk_mul_f32 v[102:103], v[36:37], v[36:37]
    v_pk_add_f32 v[100:101], v[38:39], v[36:37]
    v_pk_fma_f32 v[102:103], v[38:39], v[38:39], v[102:103]
    v_pk_add_f32 v[100:101], v[44:45], v[100:101]
    v_pk_fma_f32 v[102:103], v[44:45], v[44:45], v[102:103]
    v_pk_add_f32 v[100:101], v[46:47], v[100:101]
    v_pk_fma_f32 v[102:103], v[46:47], v[46:47], v[102:103]
    v_pk_add_f32 v[100:101], v[52:53], v[100:101]
    v_pk_fma_f32 v[102:103], v[52:53], v[52:53], v[102:103]
    v_pk_add_f32 v[100:101], v[54:55], v[100:101]
    v_pk_fma_f32 v[102:103], v[54:55], v[54:55], v[102:103]
    v_pk_add_f32 v[100:101], v[60:61], v[100:101]
    v_pk_fma_f32 v[102:103], v[60:61], v[60:61], v[102:103]
L_pad2:
    s_cbranch_execz L_hop1
    v_pk_add_f32 v[100:101], v[62:63], v[100:101]
    v_pk_fma_f32 v[102:103], v[62:63], v[62:63], v[102:103]
    v_add_f32 v104, v96, v97
    v_add_f32 v105, v98, v99
    v_add_f32 v106, v100, v101
    v_add_f32 v107, v102, v103
    s_mul_i32 s69, s3, 3584
    v_permlane32_swap_b32 v104, v106
    v_permlane32_swap_b32 v105, v107
    v_add_f32 v104, v104, v106
    v_add_f32 v105, v105, v107
    s_add_u32 s72, s69, 524288
    s_lshl_b32 s70, s61, 8
    v_permlane16_swap_b32 v104, v105
    s_add_u32 s69, s72, s70
    v_add_f32 v108, v104, v105
    v_bfi_b32 v108, s53, v30, v108
    buffer_store_dword v108, v17, s[36:39], s69 offen sc1
    s_barrier
    s_lshl_b32 s68, s61, 6
    s_add_u32 s68, s68, s3
    s_lshl_b32 s70, s68, 12
    s_add_u32 s70, s70, 5242880
    s_lshl_b32 s68, s61, 1
    s_and_b32 s69, s60, 1
    s_add_u32 s68, s68, s69
    s_lshl_b32 s68, s68, 3
    s_lshr_b32 s69, s60, 1
    s_add_u32 s68, s68, s69
    s_mul_i32 s68, s68, 128
    s_add_u32 s68, s68, 65536
    s_cmp_eq_u32 s64, 1
    s_cselect_b32 s68, s68, 20971520
    v_bfe_u32 v251, v1, 2, 2
    v_lshrrev_b32 v252, 4, v1
    v_lshlrev_b32 v251, 8, v251
    v_lshl_add_u32 v251, v252, 6, v251
    v_and_b32 v252, 3, v1
    v_lshl_add_u32 v251, v252, 4, v251
    v_add_u32 v251, s65, v251
    ds_read_b128 v[200:203], v243 offset:14720
    ds_read_b128 v[204:207], v243 offset:14784
    ds_read_b128 v[176:179], v243 offset:14848
    ds_read_b128 v[180:183], v243 offset:14912
    ds_read_b128 v[184:187], v243 offset:14976
    ds_read_b128 v[188:191], v243 offset:15040
    ds_read_b128 v[192:195], v243 offset:15104
    ds_read_b128 v[196:199], v243 offset:15168
    s_waitcnt lgkmcnt(6)
    v_mfma_f32_16x16x32_bf16 v[232:235], v[200:203], a[192:195], v[232:235]
    s_add_u32 m0, s65, 0
    s_mul_i32 s73, s74, 1792
    buffer_load_dwordx4 v240, s[24:27], s73 offen offset:0 lds
    v_mfma_f32_16x16x32_bf16 v[236:239], v[200:203], a[196:199], v[236:239]
    buffer_load_dwordx4 v241, s[24:27], s73 offen offset:1024 lds
    v_mfma_f32_16x16x32_bf16 v[232:235], v[204:207], a[200:203], v[232:235]
    s_add_u32 m0, s65, 2048
    s_mul_i32 s73, s75, 1792
    buffer_load_dwordx4 v240, s[24:27], s73 offen offset:0 lds
    v_mfma_f32_16x16x32_bf16 v[236:239], v[204:207], a[204:207], v[236:239]
    buffer_load_dwordx4 v241, s[24:27], s73 offen offset:1024 lds
    s_waitcnt lgkmcnt(4)
    v_mfma_f32_16x16x32_bf16 v[232:235], v[176:179], a[208:211], v[232:235]
    s_add_u32 m0, s65, 4096
    s_mul_i32 s73, s76, 1792
    buffer_load_dwordx4 v240, s[24:27], s73 offen offset:0 lds
    v_mfma_f32_16x16x32_bf16 v[236:239], v[176:179], a[212:215], v[236:239]
    buffer_load_dwordx4 v241, s[24:27], s73 offen offset:1024 lds
    v_mfma_f32_16x16x32_bf16 v[232:235], v[180:183], a[216:219], v[232:235]
    s_add_u32 m0, s65, 6144
    s_mul_i32 s73, s77, 1792
    v_mfma_f32_16x16x32_bf16 v[236:239], v[180:183], a[220:223], v[236:239]
    buffer_load_dwordx4 v240, s[24:27], s73 offen offset:0 lds
    s_waitcnt lgkmcnt(2)
    v_mfma_f32_16x16x32_bf16 v[232:235], v[184:187], a[224:227], v[232:235]
    buffer_load_dwordx4 v241, s[24:27], s73 offen offset:1024 lds
    v_mfma_f32_16x16x32_bf16 v[236:239], v[184:187], a[228:231], v[236:239]
    s_add_u32 m0, s65, 8192
    s_mul_i32 s73, s78, 1792
    buffer_load_dwordx4 v240, s[24:27], s73 offen offset:0 lds
    v_mfma_f32_16x16x32_bf16 v[232:235], v[188:191], a[232:235], v[232:235]
    buffer_load_dwordx4 v241, s[24:27], s73 offen offset:1024 lds
    v_mfma_f32_16x16x32_bf16 v[236:239], v[188:191], a[236:239], v[236:239]
    s_add_u32 m0, s65, 10240
    s_mul_i32 s73, s79, 1792
    buffer_load_dwordx4 v240, s[24:27], s73 offen offset:0 lds
    s_waitcnt lgkmcnt(0)
    v_mfma_f32_16x16x32_bf16 v[232:235], v[192:195], a[240:243], v[232:235]
    buffer_load_dwordx4 v241, s[24:27], s73 offen offset:1024 lds
    v_mfma_f32_16x16x32_bf16 v[236:239], v[192:195], a[244:247], v[236:239]
    s_add_u32 m0, s65, 12288
    s_mul_i32 s73, s80, 1792
    buffer_load_dwordx4 v240, s[24:27], s73 offen offset:0 lds
    v_mfma_f32_16x16x32_bf16 v[232:235], v[196:199], a[248:251], v[232:235]
    v_mfma_f32_16x16x32_bf16 v[236:239], v[196:199], a[252:255], v[236:239]
    buffer_load_dwordx4 v241, s[24:27], s73 offen offset:1024 lds
    buffer_load_dword v144, v17, s[36:39], s72 offen offset:0 sc1
    buffer_load_dword v145, v17, s[36:39], s72 offen offset:256 sc1
    buffer_load_dword v146, v17, s[36:39], s72 offen offset:512 sc1
    buffer_load_dword v147, v17, s[36:39], s72 offen offset:768 sc1
    buffer_load_dword v148, v17, s[36:39], s72 offen offset:1024 sc1
    buffer_load_dword v149, v17, s[36:39], s72 offen offset:1280 sc1
    buffer_load_dword v150, v17, s[36:39], s72 offen offset:1536 sc1
    buffer_load_dword v151, v17, s[36:39], s72 offen offset:1792 sc1
    buffer_load_dword v152, v17, s[36:39], s72 offen offset:2048 sc1
    buffer_load_dword v153, v17, s[36:39], s72 offen offset:2304 sc1
    buffer_load_dword v154, v17, s[36:39], s72 offen offset:2560 sc1
    buffer_load_dword v155, v17, s[36:39], s72 offen offset:2816 sc1
    buffer_load_dword v156, v17, s[36:39], s72 offen offset:3072 sc1
    buffer_load_dword v157, v17, s[36:39], s72 offen offset:3328 sc1
    v_mul_f32 v232, 0xbfb8aa3b, v232
    v_exp_f32 v232, v232
    s_nop 0
    v_add_f32 v232, 1.0, v232
    v_rcp_f32 v232, v232
    v_mul_f32 v236, 0xbfb8aa3b, v236
    v_exp_f32 v236, v236
    s_nop 0
    v_add_f32 v236, 1.0, v236
    v_rcp_f32 v236, v236
    ds_write_b32 v221, v232 offset:15360
    ds_write_b32 v221, v236 offset:15424
    s_add_u32 m0, s65, 28672
    s_add_u32 s73, s81, s87
    buffer_load_dwordx4 v26, s[28:31], s73 offen offset:0 lds
    buffer_load_dwordx4 v27, s[28:31], s73 offen offset:1024 lds
    buffer_load_dwordx4 v28, s[28:31], s73 offen offset:2048 lds
    buffer_load_dwordx4 v29, s[28:31], s73 offen offset:3072 lds
    s_waitcnt vmcnt(38)
    ds_read_b128 a[0:3], v14 offset:20480
    ds_read_b128 a[4:7], v14 offset:22528
    ds_read_b128 a[8:11], v15 offset:20480
    ds_read_b128 a[12:15], v15 offset:22528
    s_add_u32 m0, s65, 32768
    s_add_u32 s73, s81, s88
    buffer_load_dwordx4 v26, s[28:31], s73 offen offset:0 lds
    buffer_load_dwordx4 v27, s[28:31], s73 offen offset:1024 lds
    buffer_load_dwordx4 v28, s[28:31], s73 offen offset:2048 lds
    buffer_load_dwordx4 v29, s[28:31], s73 offen offset:3072 lds
    s_waitcnt vmcnt(38)
    ds_read_b128 a[16:19], v14 offset:24576
    ds_read_b128 a[20:23], v14 offset:26624
    ds_read_b128 a[24:27], v15 offset:24576
    ds_read_b128 a[28:31], v15 offset:26624
    s_waitcnt lgkmcnt(4)
    s_waitcnt vmcnt(8)
    v_xor_b32 v144, v30, v144
    v_xor_b32 v145, v30, v145
    v_xor_b32 v146, v30, v146
    v_xor_b32 v147, v30, v147
    v_xor_b32 v148, v30, v148
    v_xor_b32 v149, v30, v149
    v_xor_b32 v150, v30, v150
    v_xor_b32 v151, v30, v151
    v_xor_b32 v152, v30, v152
    v_xor_b32 v153, v30, v153
    v_xor_b32 v154, v30, v154
    v_xor_b32 v155, v30, v155
    v_xor_b32 v156, v30, v156
    v_xor_b32 v157, v30, v157
    v_or_b32 v248, v144, v145
    v_or3_b32 v248, v248, v146, v147
    v_or3_b32 v248, v248, v148, v149
    v_or3_b32 v248, v248, v150, v151
    v_or3_b32 v248, v248, v152, v153
    v_or3_b32 v248, v248, v154, v155
    v_or3_b32 v248, v248, v156, v157
    v_and_b32 v248, 0xff, v248
    v_cmp_ne_u32 vcc, 0, v248
    s_nop 0
    s_cmp_lg_u64 vcc, 0
    s_cbranch_scc1 L_slow_1
L_back_2:
    v_pk_add_f32 v[144:145], v[144:145], v[152:153]
    v_pk_add_f32 v[146:147], v[146:147], v[154:155]
    v_pk_add_f32 v[148:149], v[148:149], v[156:157]
    v_pk_add_f32 v[144:145], v[144:145], v[148:149]
    v_pk_add_f32 v[146:147], v[146:147], v[150:151]
    v_pk_add_f32 v[144:145], v[144:145], v[146:147]
    v_add_f32 v144, v144, v145
    v_mul_f32 v144, 0x3a924925, v144
    v_mov_b32 v145, v144
    s_nop 1
    v_permlane16_swap_b32 v144, v145
    v_fma_f32 v145, -v144, v144, v145
    v_max_f32 v145, 0, v145
    v_add_f32 v145, 0x3727c5ac, v145
    v_rsq_f32 v148, v145
    s_nop 0
    v_mul_f32 v150, v144, v148
    v_mov_b32 v152, v148
    v_mov_b32 v154, v150
    s_nop 0
    v_permlane32_swap_b32 v148, v152
    v_permlane32_swap_b32 v150, v154
    v_pk_fma_f32 v[32:33], v[32:33], v[148:149], v[150:151] op_sel_hi:[1,0,0] neg_lo:[0,0,1] neg_hi:[0,0,1]
    v_pk_fma_f32 v[34:35], v[34:35], v[148:149], v[150:151] op_sel_hi:[1,0,0] neg_lo:[0,0,1] neg_hi:[0,0,1]
    v_cvt_pk_bf16_f32 v160, v32, v33
    v_cvt_pk_bf16_f32 v161, v34, v35
    v_pk_fma_f32 v[36:37], v[36:37], v[152:153], v[154:155] op_sel_hi:[1,0,0] neg_lo:[0,0,1] neg_hi:[0,0,1]
    v_pk_fma_f32 v[38:39], v[38:39], v[152:153], v[154:155] op_sel_hi:[1,0,0] neg_lo:[0,0,1] neg_hi:[0,0,1]
    v_cvt_pk_bf16_f32 v162, v36, v37
    v_cvt_pk_bf16_f32 v163, v38, v39
    ds_write_b128 v251, v[160:163] offset:16384
    ds_read_b64_tr_b16 v[176:177], v213 offset:16384
    ds_read_b64_tr_b16 v[178:179], v213 offset:16640
    v_pk_fma_f32 v[40:41], v[40:41], v[148:149], v[150:151] op_sel_hi:[1,0,0] neg_lo:[0,0,1] neg_hi:[0,0,1]
    v_pk_fma_f32 v[42:43], v[42:43], v[148:149], v[150:151] op_sel_hi:[1,0,0] neg_lo:[0,0,1] neg_hi:[0,0,1]
    v_cvt_pk_bf16_f32 v164, v40, v41
    v_cvt_pk_bf16_f32 v165, v42, v43
    v_pk_fma_f32 v[44:45], v[44:45], v[152:153], v[154:155] op_sel_hi:[1,0,0] neg_lo:[0,0,1] neg_hi:[0,0,1]
    v_pk_fma_f32 v[46:47], v[46:47], v[152:153], v[154:155] op_sel_hi:[1,0,0] neg_lo:[0,0,1] neg_hi:[0,0,1]
    v_cvt_pk_bf16_f32 v166, v44, v45
    v_cvt_pk_bf16_f32 v167, v46, v47
    ds_write_b128 v251, v[164:167] offset:17408
    ds_read_b64_tr_b16 v[180:181], v213 offset:17408
    ds_read_b64_tr_b16 v[182:183], v213 offset:17664
    s_waitcnt lgkmcnt(3)
    buffer_store_dwordx4 v[176:179], v16, s[36:39], s70 offen offset:0 sc1
    v_pk_fma_f32 v[48:49], v[48:49], v[148:149], v[150:151] op_sel_hi:[1,0,0] neg_lo:[0,0,1] neg_hi:[0,0,1]
    v_pk_fma_f32 v[50:51], v[50:51], v[148:149], v[150:151] op_sel_hi:[1,0,0] neg_lo:[0,0,1] neg_hi:[0,0,1]
    v_cvt_pk_bf16_f32 v168, v48, v49
    v_cvt_pk_bf16_f32 v169, v50, v51
    v_pk_fma_f32 v[52:53], v[52:53], v[152:153], v[154:155] op_sel_hi:[1,0,0] neg_lo:[0,0,1] neg_hi:[0,0,1]
    v_pk_fma_f32 v[54:55], v[54:55], v[152:153], v[154:155] op_sel_hi:[1,0,0] neg_lo:[0,0,1] neg_hi:[0,0,1]
    v_cvt_pk_bf16_f32 v170, v52, v53
    v_cvt_pk_bf16_f32 v171, v54, v55
    ds_write_b128 v251, v[168:171] offset:18432
    ds_read_b64_tr_b16 v[184:185], v213 offset:18432
    ds_read_b64_tr_b16 v[186:187], v213 offset:18688
    s_waitcnt lgkmcnt(3)
    buffer_store_dwordx4 v[180:183], v16, s[36:39], s70 offen offset:1024 sc1
    v_pk_fma_f32 v[56:57], v[56:57], v[148:149], v[150:151] op_sel_hi:[1,0,0] neg_lo:[0,0,1] neg_hi:[0,0,1]
    v_pk_fma_f32 v[58:59], v[58:59], v[148:149], v[150:151] op_sel_hi:[1,0,0] neg_lo:[0,0,1] neg_hi:[0,0,1]
    v_cvt_pk_bf16_f32 v172, v56, v57
    v_cvt_pk_bf16_f32 v173, v58, v59
    v_pk_fma_f32 v[60:61], v[60:61], v[152:153], v[154:155] op_sel_hi:[1,0,0] neg_lo:[0,0,1] neg_hi:[0,0,1]
    v_pk_fma_f32 v[62:63], v[62:63], v[152:153], v[154:155] op_sel_hi:[1,0,0] neg_lo:[0,0,1] neg_hi:[0,0,1]
    v_cvt_pk_bf16_f32 v174, v60, v61
    v_cvt_pk_bf16_f32 v175, v62, v63
    ds_write_b128 v251, v[172:175] offset:19456
    ds_read_b64_tr_b16 v[188:189], v213 offset:19456
    ds_read_b64_tr_b16 v[190:191], v213 offset:19712
    s_waitcnt lgkmcnt(3)
    buffer_store_dwordx4 v[184:187], v16, s[36:39], s70 offen offset:2048 sc1
    s_waitcnt lgkmcnt(0)
    buffer_store_dwordx4 v[188:191], v16, s[36:39], s70 offen offset:3072 sc1
    s_barrier
    ds_read_b64_tr_b16 v[96:97], v10 offset:0
    ds_read_b64_tr_b16 v[98:99], v10 offset:512
    ds_read_b64_tr_b16 v[100:101], v11 offset:0
    ds_read_b64_tr_b16 v[102:103], v11 offset:512
    ds_read_b64_tr_b16 v[104:105], v12 offset:0
    ds_read_b64_tr_b16 v[106:107], v12 offset:512
    ds_read_b64_tr_b16 v[108:109], v13 offset:0
    ds_read_b64_tr_b16 v[110:111], v13 offset:512
    ds_read_b64_tr_b16 v[112:113], v10 offset:1024
    ds_read_b64_tr_b16 v[114:115], v10 offset:1536
    ds_read_b64_tr_b16 v[116:117], v11 offset:1024
    ds_read_b64_tr_b16 v[118:119], v11 offset:1536
    ds_read_b64_tr_b16 v[120:121], v12 offset:1024
    ds_read_b64_tr_b16 v[122:123], v12 offset:1536
    ds_read_b64_tr_b16 v[124:125], v13 offset:1024
    ds_read_b64_tr_b16 v[126:127], v13 offset:1536
    s_waitcnt lgkmcnt(8)
    v_mfma_f32_16x16x32_bf16 v[64:67], v[96:99], a[144:147], 0
    ds_read_b64_tr_b16 v[128:129], v10 offset:2048
    v_mfma_f32_16x16x32_bf16 v[68:71], v[96:99], a[148:151], 0
    ds_read_b64_tr_b16 v[130:131], v10 offset:2560
    buffer_load_ushort v18, v208, s[48:51], 0 offen offset:0
    v_mfma_f32_16x16x32_bf16 v[72:75], v[100:103], a[144:147], 0
    ds_read_b64_tr_b16 v[132:133], v11 offset:2048
    v_mfma_f32_16x16x32_bf16 v[76:79], v[100:103], a[148:151], 0
    ds_read_b64_tr_b16 v[134:135], v11 offset:2560
    v_mfma_f32_16x16x32_bf16 v[80:83], v[104:107], a[144:147], 0
    ds_read_b64_tr_b16 v[136:137], v12 offset:2048
    buffer_load_ushort v19, v208, s[48:51], 0 offen offset:32
    v_mfma_f32_16x16x32_bf16 v[84:87], v[104:107], a[148:151], 0
    ds_read_b64_tr_b16 v[138:139], v12 offset:2560
    v_mfma_f32_16x16x32_bf16 v[88:91], v[108:111], a[144:147], 0
    ds_read_b64_tr_b16 v[140:141], v13 offset:2048
    s_add_u32 m0, s65, 38912
    v_mfma_f32_16x16x32_bf16 v[92:95], v[108:111], a[148:151], 0
    ds_read_b64_tr_b16 v[142:143], v13 offset:2560
    buffer_load_dwordx4 v209, s[8:11], 0 offen offset:0 lds
    s_waitcnt lgkmcnt(8)
    v_mfma_f32_16x16x32_bf16 v[64:67], v[112:115], a[152:155], v[64:67]
    ds_read_b64_tr_b16 v[96:97], v10 offset:3072
    v_mfma_f32_16x16x32_bf16 v[68:71], v[112:115], a[156:159], v[68:71]
    ds_read_b64_tr_b16 v[98:99], v10 offset:3584
    buffer_load_dwordx4 v210, s[8:11], 0 offen offset:1024 lds
    v_mfma_f32_16x16x32_bf16 v[72:75], v[116:119], a[152:155], v[72:75]
    ds_read_b64_tr_b16 v[100:101], v11 offset:3072
    s_add_u32 m0, s65, 20480
    v_mfma_f32_16x16x32_bf16 v[76:79], v[116:119], a[156:159], v[76:79]
    ds_read_b64_tr_b16 v[102:103], v11 offset:3584
    s_add_u32 s73, s81, s89
    v_mfma_f32_16x16x32_bf16 v[80:83], v[120:123], a[152:155], v[80:83]
    ds_read_b64_tr_b16 v[104:105], v12 offset:3072
    buffer_load_dwordx4 v26, s[28:31], s73 offen offset:0 lds
    v_mfma_f32_16x16x32_bf16 v[84:87], v[120:123], a[156:159], v[84:87]
    ds_read_b64_tr_b16 v[106:107], v12 offset:3584
    v_mfma_f32_16x16x32_bf16 v[88:91], v[124:127], a[152:155], v[88:91]
    ds_read_b64_tr_b16 v[108:109], v13 offset:3072
    v_mfma_f32_16x16x32_bf16 v[92:95], v[124:127], a[156:159], v[92:95]
    ds_read_b64_tr_b16 v[110:111], v13 offset:3584
    buffer_load_dwordx4 v27, s[28:31], s73 offen offset:1024 lds
    s_waitcnt lgkmcnt(8)
    v_mfma_f32_16x16x32_bf16 v[64:67], v[128:131], a[160:163], v[64:67]
    ds_read_b64_tr_b16 v[112:113], v10 offset:4096
    v_mfma_f32_16x16x32_bf16 v[68:71], v[128:131], a[164:167], v[68:71]
    ds_read_b64_tr_b16 v[114:115], v10 offset:4608
    v_mfma_f32_16x16x32_bf16 v[72:75], v[132:135], a[160:163], v[72:75]
    ds_read_b64_tr_b16 v[116:117], v11 offset:4096
    v_mfma_f32_16x16x32_bf16 v[76:79], v[132:135], a[164:167], v[76:79]
    ds_read_b64_tr_b16 v[118:119], v11 offset:4608
    buffer_load_dwordx4 v28, s[28:31], s73 offen offset:2048 lds
    v_mfma_f32_16x16x32_bf16 v[80:83], v[136:139], a[160:163], v[80:83]
    ds_read_b64_tr_b16 v[120:121], v12 offset:4096
    v_mfma_f32_16x16x32_bf16 v[84:87], v[136:139], a[164:167], v[84:87]
    ds_read_b64_tr_b16 v[122:123], v12 offset:4608
    v_mfma_f32_16x16x32_bf16 v[88:91], v[140:143], a[160:163], v[88:91]
    ds_read_b64_tr_b16 v[124:125], v13 offset:4096
    v_mfma_f32_16x16x32_bf16 v[92:95], v[140:143], a[164:167], v[92:95]
    ds_read_b64_tr_b16 v[126:127], v13 offset:4608
    buffer_load_dwordx4 v29, s[28:31], s73 offen offset:3072 lds
    s_waitcnt vmcnt(16)
    ds_read_b128 a[32:35], v14 offset:28672
    ds_read_b128 a[36:39], v14 offset:30720
    ds_read_b128 a[40:43], v15 offset:28672
    ds_read_b128 a[44:47], v15 offset:30720
    s_waitcnt vmcnt(8)
    s_barrier
    s_mov_b32 exec_hi, 0
    buffer_store_dword v3, v17, s[36:39], s68 offen sc1
    s_mov_b32 exec_hi, -1
    s_waitcnt lgkmcnt(12)
    v_mfma_f32_16x16x32_bf16 v[64:67], v[96:99], a[168:171], v[64:67]
    ds_read_b64_tr_b16 v[128:129], v10 offset:5120
    s_add_u32 m0, s65, 24576
    s_add_u32 s73, s81, s90
    v_mfma_f32_16x16x32_bf16 v[68:71], v[96:99], a[172:175], v[68:71]
    ds_read_b64_tr_b16 v[130:131], v10 offset:5632
    buffer_load_dwordx4 v26, s[28:31], s73 offen offset:0 lds
    v_mfma_f32_16x16x32_bf16 v[72:75], v[100:103], a[168:171], v[72:75]
    ds_read_b64_tr_b16 v[132:133], v11 offset:5120
    v_mfma_f32_16x16x32_bf16 v[76:79], v[100:103], a[172:175], v[76:79]
    ds_read_b64_tr_b16 v[134:135], v11 offset:5632
    v_mfma_f32_16x16x32_bf16 v[80:83], v[104:107], a[168:171], v[80:83]
    ds_read_b64_tr_b16 v[136:137], v12 offset:5120
    buffer_load_dwordx4 v27, s[28:31], s73 offen offset:1024 lds
    v_mfma_f32_16x16x32_bf16 v[84:87], v[104:107], a[172:175], v[84:87]
    ds_read_b64_tr_b16 v[138:139], v12 offset:5632
    v_mfma_f32_16x16x32_bf16 v[88:91], v[108:111], a[168:171], v[88:91]
    ds_read_b64_tr_b16 v[140:141], v13 offset:5120
    v_mfma_f32_16x16x32_bf16 v[92:95], v[108:111], a[172:175], v[92:95]
    ds_read_b64_tr_b16 v[142:143], v13 offset:5632
    buffer_load_dwordx4 v28, s[28:31], s73 offen offset:2048 lds
    s_waitcnt lgkmcnt(12)
    v_mfma_f32_16x16x32_bf16 v[64:67], v[112:115], a[176:179], v[64:67]
    ds_read_b64_tr_b16 v[96:97], v10 offset:6144
    v_mfma_f32_16x16x32_bf16 v[68:71], v[112:115], a[180:183], v[68:71]
    ds_read_b64_tr_b16 v[98:99], v10 offset:6656
    v_mfma_f32_16x16x32_bf16 v[72:75], v[116:119], a[176:179], v[72:75]
    ds_read_b64_tr_b16 v[100:101], v11 offset:6144
    v_mfma_f32_16x16x32_bf16 v[76:79], v[116:119], a[180:183], v[76:79]
    ds_read_b64_tr_b16 v[102:103], v11 offset:6656
    v_mfma_f32_16x16x32_bf16 v[80:83], v[120:123], a[176:179], v[80:83]
    ds_read_b64_tr_b16 v[104:105], v12 offset:6144
    v_mfma_f32_16x16x32_bf16 v[84:87], v[120:123], a[180:183], v[84:87]
    ds_read_b64_tr_b16 v[106:107], v12 offset:6656
    v_mfma_f32_16x16x32_bf16 v[88:91], v[124:127], a[176:179], v[88:91]
    ds_read_b64_tr_b16 v[108:109], v13 offset:6144
    v_mfma_f32_16x16x32_bf16 v[92:95], v[124:127], a[180:183], v[92:95]
    ds_read_b64_tr_b16 v[110:111], v13 offset:6656
    buffer_load_dwordx4 v29, s[28:31], s73 offen offset:3072 lds
    ds_read_b128 a[48:51], v14 offset:32768
    ds_read_b128 a[52:55], v14 offset:34816
    ds_read_b128 a[56:59], v15 offset:32768
    ds_read_b128 a[60:63], v15 offset:34816
    s_waitcnt lgkmcnt(15)
    s_add_u32 m0, s65, 28672
    s_waitcnt lgkmcnt(12)
    v_mfma_f32_16x16x32_bf16 v[64:67], v[128:131], a[184:187], v[64:67]
    ds_read_b64_tr_b16 v[112:113], v10 offset:7168
    s_add_u32 s73, s81, s91
    v_mfma_f32_16x16x32_bf16 v[68:71], v[128:131], a[188:191], v[68:71]
    ds_read_b64_tr_b16 v[114:115], v10 offset:7680
    buffer_load_dwordx4 v26, s[28:31], s73 offen offset:0 lds
    v_mfma_f32_16x16x32_bf16 v[72:75], v[132:135], a[184:187], v[72:75]
    ds_read_b64_tr_b16 v[116:117], v11 offset:7168
    v_mfma_f32_16x16x32_bf16 v[76:79], v[132:135], a[188:191], v[76:79]
    ds_read_b64_tr_b16 v[118:119], v11 offset:7680
    v_mfma_f32_16x16x32_bf16 v[80:83], v[136:139], a[184:187], v[80:83]
    ds_read_b64_tr_b16 v[120:121], v12 offset:7168
    buffer_load_dwordx4 v27, s[28:31], s73 offen offset:1024 lds
    v_mfma_f32_16x16x32_bf16 v[84:87], v[136:139], a[188:191], v[84:87]
    ds_read_b64_tr_b16 v[122:123], v12 offset:7680
    v_mfma_f32_16x16x32_bf16 v[88:91], v[140:143], a[184:187], v[88:91]
    ds_read_b64_tr_b16 v[124:125], v13 offset:7168
    v_mfma_f32_16x16x32_bf16 v[92:95], v[140:143], a[188:191], v[92:95]
    ds_read_b64_tr_b16 v[126:127], v13 offset:7680
    buffer_load_dwordx4 v28, s[28:31], s73 offen offset:2048 lds
    s_waitcnt lgkmcnt(12)
    v_mfma_f32_16x16x32_bf16 v[64:67], v[96:99], a[192:195], v[64:67]
    ds_read_b64_tr_b16 v[128:129], v10 offset:8192
    v_mfma_f32_16x16x32_bf16 v[68:71], v[96:99], a[196:199], v[68:71]
    ds_read_b64_tr_b16 v[130:131], v10 offset:8704
    v_mfma_f32_16x16x32_bf16 v[72:75], v[100:103], a[192:195], v[72:75]
    ds_read_b64_tr_b16 v[132:133], v11 offset:8192
    v_mfma_f32_16x16x32_bf16 v[76:79], v[100:103], a[196:199], v[76:79]
    ds_read_b64_tr_b16 v[134:135], v11 offset:8704
    v_mfma_f32_16x16x32_bf16 v[80:83], v[104:107], a[192:195], v[80:83]
    ds_read_b64_tr_b16 v[136:137], v12 offset:8192
    v_mfma_f32_16x16x32_bf16 v[84:87], v[104:107], a[196:199], v[84:87]
    ds_read_b64_tr_b16 v[138:139], v12 offset:8704
    v_mfma_f32_16x16x32_bf16 v[88:91], v[108:111], a[192:195], v[88:91]
    ds_read_b64_tr_b16 v[140:141], v13 offset:8192
    v_mfma_f32_16x16x32_bf16 v[92:95], v[108:111], a[196:199], v[92:95]
    ds_read_b64_tr_b16 v[142:143], v13 offset:8704
    buffer_load_dwordx4 v29, s[28:31], s73 offen offset:3072 lds
    s_waitcnt vmcnt(9)
    ds_read_b128 a[64:67], v14 offset:20480
    ds_read_b128 a[68:71], v14 offset:22528
    ds_read_b128 a[72:75], v15 offset:20480
    ds_read_b128 a[76:79], v15 offset:22528
    s_waitcnt lgkmcnt(15)
    s_add_u32 m0, s65, 32768
    s_waitcnt lgkmcnt(12)
    v_mfma_f32_16x16x32_bf16 v[64:67], v[112:115], a[200:203], v[64:67]
    ds_read_b64_tr_b16 v[96:97], v10 offset:9216
    s_add_u32 s73, s81, s92
    v_mfma_f32_16x16x32_bf16 v[68:71], v[112:115], a[204:207], v[68:71]
    ds_read_b64_tr_b16 v[98:99], v10 offset:9728
    buffer_load_dwordx4 v26, s[28:31], s73 offen offset:0 lds
    v_mfma_f32_16x16x32_bf16 v[72:75], v[116:119], a[200:203], v[72:75]
    ds_read_b64_tr_b16 v[100:101], v11 offset:9216
    v_mfma_f32_16x16x32_bf16 v[76:79], v[116:119], a[204:207], v[76:79]
    ds_read_b64_tr_b16 v[102:103], v11 offset:9728
    v_mfma_f32_16x16x32_bf16 v[80:83], v[120:123], a[200:203], v[80:83]
    ds_read_b64_tr_b16 v[104:105], v12 offset:9216
    buffer_load_dwordx4 v27, s[28:31], s73 offen offset:1024 lds
    v_mfma_f32_16x16x32_bf16 v[84:87], v[120:123], a[204:207], v[84:87]
    ds_read_b64_tr_b16 v[106:107], v12 offset:9728
    v_mfma_f32_16x16x32_bf16 v[88:91], v[124:127], a[200:203], v[88:91]
    ds_read_b64_tr_b16 v[108:109], v13 offset:9216
    v_mfma_f32_16x16x32_bf16 v[92:95], v[124:127], a[204:207], v[92:95]
    ds_read_b64_tr_b16 v[110:111], v13 offset:9728
    buffer_load_dwordx4 v28, s[28:31], s73 offen offset:2048 lds
    buffer_load_dword v220, v219, s[36:39], s16 offen sc1
    s_waitcnt lgkmcnt(12)
    v_mfma_f32_16x16x32_bf16 v[64:67], v[128:131], a[208:211], v[64:67]
    ds_read_b64_tr_b16 v[112:113], v10 offset:10240
    v_mfma_f32_16x16x32_bf16 v[68:71], v[128:131], a[212:215], v[68:71]
    ds_read_b64_tr_b16 v[114:115], v10 offset:10752
    v_mfma_f32_16x16x32_bf16 v[72:75], v[132:135], a[208:211], v[72:75]
    ds_read_b64_tr_b16 v[116:117], v11 offset:10240
    v_mfma_f32_16x16x32_bf16 v[76:79], v[132:135], a[212:215], v[76:79]
    ds_read_b64_tr_b16 v[118:119], v11 offset:10752
    v_mfma_f32_16x16x32_bf16 v[80:83], v[136:139], a[208:211], v[80:83]
    ds_read_b64_tr_b16 v[120:121], v12 offset:10240
    v_mfma_f32_16x16x32_bf16 v[84:87], v[136:139], a[212:215], v[84:87]
    ds_read_b64_tr_b16 v[122:123], v12 offset:10752
    v_mfma_f32_16x16x32_bf16 v[88:91], v[140:143], a[208:211], v[88:91]
    ds_read_b64_tr_b16 v[124:125], v13 offset:10240
    v_mfma_f32_16x16x32_bf16 v[92:95], v[140:143], a[212:215], v[92:95]
    ds_read_b64_tr_b16 v[126:127], v13 offset:10752
    buffer_load_dwordx4 v29, s[28:31], s73 offen offset:3072 lds
    s_waitcnt vmcnt(9)
    ds_read_b128 a[80:83], v14 offset:24576
    ds_read_b128 a[84:87], v14 offset:26624
    ds_read_b128 a[88:91], v15 offset:24576
    ds_read_b128 a[92:95], v15 offset:26624
    s_waitcnt lgkmcnt(15)
    s_add_u32 m0, s65, 20480
    s_waitcnt lgkmcnt(12)
    v_mfma_f32_16x16x32_bf16 v[64:67], v[96:99], a[216:219], v[64:67]
    ds_read_b64_tr_b16 v[128:129], v10 offset:11264
    s_add_u32 s73, s82, s85
    v_mfma_f32_16x16x32_bf16 v[68:71], v[96:99], a[220:223], v[68:71]
    ds_read_b64_tr_b16 v[130:131], v10 offset:11776
    buffer_load_dwordx4 v26, s[28:31], s73 offen offset:0 lds
    v_mfma_f32_16x16x32_bf16 v[72:75], v[100:103], a[216:219], v[72:75]
    ds_read_b64_tr_b16 v[132:133], v11 offset:11264
    v_mfma_f32_16x16x32_bf16 v[76:79], v[100:103], a[220:223], v[76:79]
    ds_read_b64_tr_b16 v[134:135], v11 offset:11776
    v_mfma_f32_16x16x32_bf16 v[80:83], v[104:107], a[216:219], v[80:83]
    ds_read_b64_tr_b16 v[136:137], v12 offset:11264
    buffer_load_dwordx4 v27, s[28:31], s73 offen offset:1024 lds
    v_mfma_f32_16x16x32_bf16 v[84:87], v[104:107], a[220:223], v[84:87]
    ds_read_b64_tr_b16 v[138:139], v12 offset:11776
    v_mfma_f32_16x16x32_bf16 v[88:91], v[108:111], a[216:219], v[88:91]
    ds_read_b64_tr_b16 v[140:141], v13 offset:11264
    v_mfma_f32_16x16x32_bf16 v[92:95], v[108:111], a[220:223], v[92:95]
    ds_read_b64_tr_b16 v[142:143], v13 offset:11776
    buffer_load_dwordx4 v28, s[28:31], s73 offen offset:2048 lds
    s_waitcnt lgkmcnt(12)
    v_mfma_f32_16x16x32_bf16 v[64:67], v[112:115], a[224:227], v[64:67]
    ds_read_b64_tr_b16 v[96:97], v10 offset:12288
    v_mfma_f32_16x16x32_bf16 v[68:71], v[112:115], a[228:231], v[68:71]
    ds_read_b64_tr_b16 v[98:99], v10 offset:12800
    v_mfma_f32_16x16x32_bf16 v[72:75], v[116:119], a[224:227], v[72:75]
    ds_read_b64_tr_b16 v[100:101], v11 offset:12288
    v_mfma_f32_16x16x32_bf16 v[76:79], v[116:119], a[228:231], v[76:79]
    ds_read_b64_tr_b16 v[102:103], v11 offset:12800
    v_mfma_f32_16x16x32_bf16 v[80:83], v[120:123], a[224:227], v[80:83]
    ds_read_b64_tr_b16 v[104:105], v12 offset:12288
    v_mfma_f32_16x16x32_bf16 v[84:87], v[120:123], a[228:231], v[84:87]
    ds_read_b64_tr_b16 v[106:107], v12 offset:12800
    v_mfma_f32_16x16x32_bf16 v[88:91], v[124:127], a[224:227], v[88:91]
    ds_read_b64_tr_b16 v[108:109], v13 offset:12288
    v_mfma_f32_16x16x32_bf16 v[92:95], v[124:127], a[228:231], v[92:95]
    ds_read_b64_tr_b16 v[110:111], v13 offset:12800
    buffer_load_dwordx4 v29, s[28:31], s73 offen offset:3072 lds
    s_waitcnt vmcnt(9)
    ds_read_b128 a[96:99], v14 offset:28672
    ds_read_b128 a[100:103], v14 offset:30720
    ds_read_b128 a[104:107], v15 offset:28672
    ds_read_b128 a[108:111], v15 offset:30720
    s_waitcnt lgkmcnt(15)
    s_add_u32 m0, s65, 24576
    s_waitcnt lgkmcnt(12)
    v_mfma_f32_16x16x32_bf16 v[64:67], v[128:131], a[232:235], v[64:67]
    ds_read_b64_tr_b16 v[112:113], v10 offset:13312
    s_add_u32 s73, s82, s86
    v_mfma_f32_16x16x32_bf16 v[68:71], v[128:131], a[236:239], v[68:71]
    ds_read_b64_tr_b16 v[114:115], v10 offset:13824
    buffer_load_dwordx4 v26, s[28:31], s73 offen offset:0 lds
    v_mfma_f32_16x16x32_bf16 v[72:75], v[132:135], a[232:235], v[72:75]
    ds_read_b64_tr_b16 v[116:117], v11 offset:13312
    v_mfma_f32_16x16x32_bf16 v[76:79], v[132:135], a[236:239], v[76:79]
    ds_read_b64_tr_b16 v[118:119], v11 offset:13824
    v_mfma_f32_16x16x32_bf16 v[80:83], v[136:139], a[232:235], v[80:83]
    ds_read_b64_tr_b16 v[120:121], v12 offset:13312
    buffer_load_dwordx4 v27, s[28:31], s73 offen offset:1024 lds
    v_mfma_f32_16x16x32_bf16 v[84:87], v[136:139], a[236:239], v[84:87]
    ds_read_b64_tr_b16 v[122:123], v12 offset:13824
    v_mfma_f32_16x16x32_bf16 v[88:91], v[140:143], a[232:235], v[88:91]
    ds_read_b64_tr_b16 v[124:125], v13 offset:13312
    v_mfma_f32_16x16x32_bf16 v[92:95], v[140:143], a[236:239], v[92:95]
    ds_read_b64_tr_b16 v[126:127], v13 offset:13824
    buffer_load_dwordx4 v28, s[28:31], s73 offen offset:2048 lds
    buffer_load_dwordx4 v29, s[28:31], s73 offen offset:3072 lds
    s_waitcnt vmcnt(9)
    v_cmp_ne_u32 vcc, s15, v220
    s_nop 0
    s_cmp_lg_u64 vcc, 0
    s_cbranch_scc1 L_slow_3
L_back_4:
    s_barrier
    s_waitcnt lgkmcnt(12)
    v_mfma_f32_16x16x32_bf16 v[64:67], v[96:99], a[240:243], v[64:67]
    s_add_u32 m0, s65, 16384
    s_add_u32 s73, s93, s97
    v_mfma_f32_16x16x32_bf16 v[68:71], v[96:99], a[244:247], v[68:71]
    buffer_load_dwordx4 v16, s[36:39], s73 offen offset:0 sc1 lds
    v_mfma_f32_16x16x32_bf16 v[72:75], v[100:103], a[240:243], v[72:75]
    v_mfma_f32_16x16x32_bf16 v[76:79], v[100:103], a[244:247], v[76:79]
    buffer_load_dwordx4 v16, s[36:39], s73 offen offset:1024 sc1 lds
    v_mfma_f32_16x16x32_bf16 v[80:83], v[104:107], a[240:243], v[80:83]
    v_mfma_f32_16x16x32_bf16 v[84:87], v[104:107], a[244:247], v[84:87]
    buffer_load_dwordx4 v16, s[36:39], s73 offen offset:2048 sc1 lds
    v_mfma_f32_16x16x32_bf16 v[88:91], v[108:111], a[240:243], v[88:91]
    v_mfma_f32_16x16x32_bf16 v[92:95], v[108:111], a[244:247], v[92:95]
    buffer_load_dwordx4 v16, s[36:39], s73 offen offset:3072 sc1 lds
    s_add_u32 m0, s65, 0
    s_add_u32 s73, s93, s98
    s_waitcnt lgkmcnt(0)
    v_mfma_f32_16x16x32_bf16 v[64:67], v[112:115], a[248:251], v[64:67]
    v_mfma_f32_16x16x32_bf16 v[68:71], v[112:115], a[252:255], v[68:71]
    buffer_load_dwordx4 v16, s[36:39], s73 offen offset:0 sc1 lds
    v_mfma_f32_16x16x32_bf16 v[72:75], v[116:119], a[248:251], v[72:75]
    v_mfma_f32_16x16x32_bf16 v[76:79], v[116:119], a[252:255], v[76:79]
    buffer_load_dwordx4 v16, s[36:39], s73 offen offset:1024 sc1 lds
    v_mfma_f32_16x16x32_bf16 v[80:83], v[120:123], a[248:251], v[80:83]
    v_mfma_f32_16x16x32_bf16 v[84:87], v[120:123], a[252:255], v[84:87]
L_pad3:
    s_cbranch_execz L_hop1
    buffer_load_dwordx4 v16, s[36:39], s73 offen offset:2048 sc1 lds
    v_mfma_f32_16x16x32_bf16 v[88:91], v[124:127], a[248:251], v[88:91]
    v_mfma_f32_16x16x32_bf16 v[92:95], v[124:127], a[252:255], v[92:95]
    buffer_load_dwordx4 v16, s[36:39], s73 offen offset:3072 sc1 lds
    s_add_u32 m0, s65, 4096
    s_add_u32 s73, s93, s99
    v_pk_mul_f32 v[248:249], v[64:65], v[64:65]
    v_pk_fma_f32 v[248:249], v[248:249], v[22:23], v[20:21]
    buffer_load_dwordx4 v16, s[36:39], s73 offen offset:0 sc1 lds
    v_pk_mul_f32 v[248:249], v[248:249], v[64:65]
    v_exp_f32 v248, v248
    buffer_load_dwordx4 v16, s[36:39], s73 offen offset:1024 sc1 lds
    v_pk_mul_f32 v[250:251], v[66:67], v[66:67]
    v_pk_fma_f32 v[250:251], v[250:251], v[22:23], v[20:21]
    buffer_load_dwordx4 v16, s[36:39], s73 offen offset:2048 sc1 lds
    v_exp_f32 v249, v249
    v_pk_mul_f32 v[250:251], v[250:251], v[66:67]
    buffer_load_dwordx4 v16, s[36:39], s73 offen offset:3072 sc1 lds
    v_exp_f32 v250, v250
    v_pk_mul_f32 v[252:253], v[68:69], v[68:69]
    s_waitcnt vmcnt(20)
    v_pk_fma_f32 v[252:253], v[252:253], v[22:23], v[20:21]
    v_exp_f32 v251, v251
    ds_read_b128 a[112:115], v14 offset:32768
    v_pk_mul_f32 v[252:253], v[252:253], v[68:69]
    v_exp_f32 v252, v252
    ds_read_b128 a[116:119], v14 offset:34816
    v_pk_mul_f32 v[254:255], v[70:71], v[70:71]
    v_pk_fma_f32 v[254:255], v[254:255], v[22:23], v[20:21]
    ds_read_b128 a[120:123], v15 offset:32768
    v_exp_f32 v253, v253
    v_pk_mul_f32 v[254:255], v[254:255], v[70:71]
    ds_read_b128 a[124:127], v15 offset:34816
    v_exp_f32 v254, v254
    v_pk_add_f32 v[248:249], v[248:249], v[24:25]
    s_waitcnt vmcnt(16)
    v_pk_add_f32 v[250:251], v[250:251], v[24:25]
    v_exp_f32 v255, v255
    ds_read_b128 a[128:131], v14 offset:20480
    v_pk_add_f32 v[252:253], v[252:253], v[24:25]
    v_rcp_f32 v248, v248
    ds_read_b128 a[132:135], v14 offset:22528
    v_pk_add_f32 v[254:255], v[254:255], v[24:25]
    v_rcp_f32 v249, v249
    ds_read_b128 a[136:139], v15 offset:20480
    v_rcp_f32 v250, v250
    v_pk_mul_f32 v[64:65], v[64:65], v[248:249]
    ds_read_b128 a[140:143], v15 offset:22528
    v_rcp_f32 v251, v251
    v_rcp_f32 v252, v252
    s_waitcnt vmcnt(12)
    v_pk_mul_f32 v[66:67], v[66:67], v[250:251]
    v_rcp_f32 v253, v253
    ds_read_b128 a[144:147], v14 offset:24576
    v_rcp_f32 v254, v254
    v_pk_mul_f32 v[68:69], v[68:69], v[252:253]
    ds_read_b128 a[148:151], v14 offset:26624
    v_rcp_f32 v255, v255
    s_nop 0
    v_pk_mul_f32 v[70:71], v[70:71], v[254:255]
    ds_read_b128 a[152:155], v15 offset:24576
    ds_read_b128 a[156:159], v15 offset:26624
    s_add_u32 m0, s65, 28672
    s_add_u32 s73, s82, s87
    buffer_load_dwordx4 v26, s[28:31], s73 offen offset:0 lds
    buffer_load_dwordx4 v27, s[28:31], s73 offen offset:1024 lds
    buffer_load_dwordx4 v28, s[28:31], s73 offen offset:2048 lds
    buffer_load_dwordx4 v29, s[28:31], s73 offen offset:3072 lds
    s_waitcnt lgkmcnt(8)
    s_add_u32 m0, s65, 32768
    s_add_u32 s73, s82, s88
    buffer_load_dwordx4 v26, s[28:31], s73 offen offset:0 lds
    buffer_load_dwordx4 v27, s[28:31], s73 offen offset:1024 lds
    buffer_load_dwordx4 v28, s[28:31], s73 offen offset:2048 lds
    buffer_load_dwordx4 v29, s[28:31], s73 offen offset:3072 lds
    s_waitcnt lgkmcnt(0)
    s_waitcnt vmcnt(16)
    s_barrier
    ds_read_b32 v244, v222 offset:15360
    ds_read_b32 v246, v222 offset:15424
    ds_read_b128 v[96:99], v211 offset:16384
    ds_read_b128 v[100:103], v211 offset:17408
    ds_read_b128 v[104:107], v211 offset:18432
    ds_read_b128 v[108:111], v211 offset:19456
    ds_read_b128 v[112:115], v211 offset:57344
    ds_read_b128 v[116:119], v211 offset:58368
    ds_read_b128 v[120:123], v211 offset:59392
    ds_read_b128 v[124:127], v211 offset:60416
    s_waitcnt lgkmcnt(4)
    v_mfma_f32_16x16x32_bf16 v[144:147], v[96:99], a[0:3], 0
    s_add_u32 m0, s65, 8192
    v_lshlrev_b32 v56, 16, v18
    v_mfma_f32_16x16x32_bf16 v[148:151], v[96:99], a[4:7], 0
    ds_read_b128 v[128:131], v212 offset:16384
    s_add_u32 s73, s93, s100
    v_mfma_f32_16x16x32_bf16 v[152:155], v[100:103], a[0:3], 0
    buffer_load_dwordx4 v16, s[36:39], s73 offen offset:0 sc1 lds
    v_mfma_f32_16x16x32_bf16 v[156:159], v[100:103], a[4:7], 0
    ds_read_b128 v[132:135], v212 offset:17408
    v_lshlrev_b32 v57, 16, v18
    v_mfma_f32_16x16x32_bf16 v[160:163], v[104:107], a[0:3], 0
    v_lshlrev_b32 v58, 16, v18
    v_lshlrev_b32 v59, 16, v18
    v_mfma_f32_16x16x32_bf16 v[164:167], v[104:107], a[4:7], 0
    ds_read_b128 v[136:139], v212 offset:18432
    v_lshlrev_b32 v60, 16, v19
    v_mfma_f32_16x16x32_bf16 v[168:171], v[108:111], a[0:3], 0
    v_lshlrev_b32 v61, 16, v19
    v_lshlrev_b32 v62, 16, v19
    v_mfma_f32_16x16x32_bf16 v[172:175], v[108:111], a[4:7], 0
    ds_read_b128 v[140:143], v212 offset:19456
    s_waitcnt lgkmcnt(4)
    v_mfma_f32_16x16x32_bf16 v[144:147], v[112:115], a[8:11], v[144:147]
    v_lshlrev_b32 v63, 16, v19
    v_mul_f32 v248, v72, v72
    v_mfma_f32_16x16x32_bf16 v[148:151], v[112:115], a[12:15], v[148:151]
    ds_read_b128 v[96:99], v212 offset:57344
    v_mul_f32 v249, v73, v73
    v_mfma_f32_16x16x32_bf16 v[152:155], v[116:119], a[8:11], v[152:155]
    buffer_load_dwordx4 v16, s[36:39], s73 offen offset:1024 sc1 lds
    v_mfma_f32_16x16x32_bf16 v[156:159], v[116:119], a[12:15], v[156:159]
    ds_read_b128 v[100:103], v212 offset:58368
    s_waitcnt vmcnt(14)
    v_mfma_f32_16x16x32_bf16 v[160:163], v[120:123], a[8:11], v[160:163]
    s_barrier
    v_mul_f32 v250, v74, v74
    v_mfma_f32_16x16x32_bf16 v[164:167], v[120:123], a[12:15], v[164:167]
    ds_read_b128 v[104:107], v212 offset:59392
    v_mul_f32 v251, v75, v75
    v_mfma_f32_16x16x32_bf16 v[168:171], v[124:127], a[8:11], v[168:171]
    buffer_load_dwordx4 v16, s[36:39], s73 offen offset:2048 sc1 lds
    v_mfma_f32_16x16x32_bf16 v[172:175], v[124:127], a[12:15], v[172:175]
    ds_read_b128 v[108:111], v212 offset:60416
    s_waitcnt lgkmcnt(4)
    s_waitcnt vmcnt(7)
    v_mfma_f32_16x16x32_bf16 v[144:147], v[128:131], a[16:19], v[144:147]
    ds_read_b128 a[160:163], v14 offset:28672
    v_mul_f32 v252, v76, v76
    v_mfma_f32_16x16x32_bf16 v[148:151], v[128:131], a[20:23], v[148:151]
    ds_read_b128 v[112:115], v211 offset:0
    v_mul_f32 v253, v77, v77
    v_mfma_f32_16x16x32_bf16 v[152:155], v[132:135], a[16:19], v[152:155]
    ds_read_b128 a[164:167], v14 offset:30720
    buffer_load_dwordx4 v16, s[36:39], s73 offen offset:3072 sc1 lds
    v_mfma_f32_16x16x32_bf16 v[156:159], v[132:135], a[20:23], v[156:159]
    ds_read_b128 v[116:119], v211 offset:1024
    v_mul_f32 v254, v78, v78
    v_mfma_f32_16x16x32_bf16 v[160:163], v[136:139], a[16:19], v[160:163]
    ds_read_b128 a[168:171], v15 offset:28672
    s_add_u32 m0, s65, 12288
    v_mfma_f32_16x16x32_bf16 v[164:167], v[136:139], a[20:23], v[164:167]
    ds_read_b128 v[120:123], v211 offset:2048
    s_add_u32 s73, s94, s97
    v_mfma_f32_16x16x32_bf16 v[168:171], v[140:143], a[16:19], v[168:171]
    ds_read_b128 a[172:175], v15 offset:30720
    buffer_load_dwordx4 v16, s[36:39], s73 offen offset:0 sc1 lds
    v_mfma_f32_16x16x32_bf16 v[172:175], v[140:143], a[20:23], v[172:175]
    ds_read_b128 v[124:127], v211 offset:3072
    s_waitcnt lgkmcnt(8)
    s_waitcnt vmcnt(5)
    v_mfma_f32_16x16x32_bf16 v[144:147], v[96:99], a[24:27], v[144:147]
    ds_read_b128 a[176:179], v14 offset:32768
    v_mul_f32 v255, v79, v79
    v_mfma_f32_16x16x32_bf16 v[148:151], v[96:99], a[28:31], v[148:151]
    ds_read_b128 v[128:131], v211 offset:40960
    v_fma_f32 v248, v248, v22, v20
    v_mfma_f32_16x16x32_bf16 v[152:155], v[100:103], a[24:27], v[152:155]
    ds_read_b128 a[180:183], v14 offset:34816
    buffer_load_dwordx4 v16, s[36:39], s73 offen offset:1024 sc1 lds
    v_mfma_f32_16x16x32_bf16 v[156:159], v[100:103], a[28:31], v[156:159]
    ds_read_b128 v[132:135], v211 offset:41984
    v_fma_f32 v249, v249, v22, v20
    v_mfma_f32_16x16x32_bf16 v[160:163], v[104:107], a[24:27], v[160:163]
    ds_read_b128 a[184:187], v15 offset:32768
    v_fma_f32 v250, v250, v22, v20
    v_mfma_f32_16x16x32_bf16 v[164:167], v[104:107], a[28:31], v[164:167]
    ds_read_b128 v[136:139], v211 offset:43008
    v_fma_f32 v251, v251, v22, v20
    v_mfma_f32_16x16x32_bf16 v[168:171], v[108:111], a[24:27], v[168:171]
    ds_read_b128 a[188:191], v15 offset:34816
    buffer_load_dwordx4 v16, s[36:39], s73 offen offset:2048 sc1 lds
    v_mfma_f32_16x16x32_bf16 v[172:175], v[108:111], a[28:31], v[172:175]
    ds_read_b128 v[140:143], v211 offset:44032
    s_waitcnt lgkmcnt(8)
    v_mfma_f32_16x16x32_bf16 v[144:147], v[112:115], a[32:35], v[144:147]
    v_fma_f32 v252, v252, v22, v20
    v_fma_f32 v253, v253, v22, v20
    v_mfma_f32_16x16x32_bf16 v[148:151], v[112:115], a[36:39], v[148:151]
    ds_read_b128 v[96:99], v212 offset:0
    v_fma_f32 v254, v254, v22, v20
    v_mfma_f32_16x16x32_bf16 v[152:155], v[116:119], a[32:35], v[152:155]
    buffer_load_dwordx4 v16, s[36:39], s73 offen offset:3072 sc1 lds
    v_mfma_f32_16x16x32_bf16 v[156:159], v[116:119], a[36:39], v[156:159]
    ds_read_b128 v[100:103], v212 offset:1024
    v_mfma_f32_16x16x32_bf16 v[160:163], v[120:123], a[32:35], v[160:163]
    s_add_u32 m0, s65, 20480
    v_fma_f32 v255, v255, v22, v20
    v_mfma_f32_16x16x32_bf16 v[164:167], v[120:123], a[36:39], v[164:167]
    ds_read_b128 v[104:107], v212 offset:2048
    s_add_u32 s73, s82, s89
    v_mfma_f32_16x16x32_bf16 v[168:171], v[124:127], a[32:35], v[168:171]
    buffer_load_dwordx4 v26, s[28:31], s73 offen offset:0 lds
    v_mfma_f32_16x16x32_bf16 v[172:175], v[124:127], a[36:39], v[172:175]
    ds_read_b128 v[108:111], v212 offset:3072
    s_waitcnt lgkmcnt(4)
    v_mfma_f32_16x16x32_bf16 v[144:147], v[128:131], a[40:43], v[144:147]
    v_mul_f32 v248, v248, v72
    v_mul_f32 v249, v249, v73
    v_mfma_f32_16x16x32_bf16 v[148:151], v[128:131], a[44:47], v[148:151]
    ds_read_b128 v[112:115], v212 offset:40960
    v_mul_f32 v250, v250, v74
    v_mfma_f32_16x16x32_bf16 v[152:155], v[132:135], a[40:43], v[152:155]
    buffer_load_dwordx4 v27, s[28:31], s73 offen offset:1024 lds
    v_mfma_f32_16x16x32_bf16 v[156:159], v[132:135], a[44:47], v[156:159]
    ds_read_b128 v[116:119], v212 offset:41984
    v_mfma_f32_16x16x32_bf16 v[160:163], v[136:139], a[40:43], v[160:163]
    s_barrier
    v_mul_f32 v251, v251, v75
    v_mfma_f32_16x16x32_bf16 v[164:167], v[136:139], a[44:47], v[164:167]
    ds_read_b128 v[120:123], v212 offset:43008
    v_mul_f32 v252, v252, v76
    v_mfma_f32_16x16x32_bf16 v[168:171], v[140:143], a[40:43], v[168:171]
    v_exp_f32 v248, v248
    v_mfma_f32_16x16x32_bf16 v[172:175], v[140:143], a[44:47], v[172:175]
    ds_read_b128 v[124:127], v212 offset:44032
    s_waitcnt lgkmcnt(4)
    v_mfma_f32_16x16x32_bf16 v[144:147], v[96:99], a[48:51], v[144:147]
    v_exp_f32 v249, v249
    v_mfma_f32_16x16x32_bf16 v[148:151], v[96:99], a[52:55], v[148:151]
    ds_read_b128 v[128:131], v211 offset:4096
    v_mul_f32 v253, v253, v77
    v_mfma_f32_16x16x32_bf16 v[152:155], v[100:103], a[48:51], v[152:155]
    buffer_load_dwordx4 v28, s[28:31], s73 offen offset:2048 lds
    v_mfma_f32_16x16x32_bf16 v[156:159], v[100:103], a[52:55], v[156:159]
    ds_read_b128 v[132:135], v211 offset:5120
    v_mul_f32 v254, v254, v78
    v_mfma_f32_16x16x32_bf16 v[160:163], v[104:107], a[48:51], v[160:163]
    v_exp_f32 v250, v250
    v_mfma_f32_16x16x32_bf16 v[164:167], v[104:107], a[52:55], v[164:167]
    ds_read_b128 v[136:139], v211 offset:6144
    v_mul_f32 v255, v255, v79
    v_mfma_f32_16x16x32_bf16 v[168:171], v[108:111], a[48:51], v[168:171]
    buffer_load_dwordx4 v29, s[28:31], s73 offen offset:3072 lds
    v_mfma_f32_16x16x32_bf16 v[172:175], v[108:111], a[52:55], v[172:175]
    ds_read_b128 v[140:143], v211 offset:7168
    s_waitcnt lgkmcnt(4)
    v_mfma_f32_16x16x32_bf16 v[144:147], v[112:115], a[56:59], v[144:147]
    s_add_u32 m0, s65, 16384
    v_add_f32 v248, 1.0, v248
    v_mfma_f32_16x16x32_bf16 v[148:151], v[112:115], a[60:63], v[148:151]
    ds_read_b128 v[96:99], v211 offset:45056
    s_add_u32 s73, s94, s98
    v_mfma_f32_16x16x32_bf16 v[152:155], v[116:119], a[56:59], v[152:155]
    buffer_load_dwordx4 v16, s[36:39], s73 offen offset:0 sc1 lds
    v_mfma_f32_16x16x32_bf16 v[156:159], v[116:119], a[60:63], v[156:159]
    ds_read_b128 v[100:103], v211 offset:46080
    v_add_f32 v249, 1.0, v249
    v_mfma_f32_16x16x32_bf16 v[160:163], v[120:123], a[56:59], v[160:163]
    v_exp_f32 v251, v251
    v_mfma_f32_16x16x32_bf16 v[164:167], v[120:123], a[60:63], v[164:167]
    ds_read_b128 v[104:107], v211 offset:47104
    v_add_f32 v250, 1.0, v250
    v_mfma_f32_16x16x32_bf16 v[168:171], v[124:127], a[56:59], v[168:171]
    buffer_load_dwordx4 v16, s[36:39], s73 offen offset:1024 sc1 lds
    v_mfma_f32_16x16x32_bf16 v[172:175], v[124:127], a[60:63], v[172:175]
    ds_read_b128 v[108:111], v211 offset:48128
    s_waitcnt lgkmcnt(4)
    v_mfma_f32_16x16x32_bf16 v[144:147], v[128:131], a[64:67], v[144:147]
    v_exp_f32 v252, v252
    v_mfma_f32_16x16x32_bf16 v[148:151], v[128:131], a[68:71], v[148:151]
    ds_read_b128 v[112:115], v212 offset:4096
    v_add_f32 v251, 1.0, v251
    v_mfma_f32_16x16x32_bf16 v[152:155], v[132:135], a[64:67], v[152:155]
    buffer_load_dwordx4 v16, s[36:39], s73 offen offset:2048 sc1 lds
    v_mfma_f32_16x16x32_bf16 v[156:159], v[132:135], a[68:71], v[156:159]
    ds_read_b128 v[116:119], v212 offset:5120
    v_add_f32 v252, 1.0, v252
    v_mfma_f32_16x16x32_bf16 v[160:163], v[136:139], a[64:67], v[160:163]
    v_exp_f32 v253, v253
    v_mfma_f32_16x16x32_bf16 v[164:167], v[136:139], a[68:71], v[164:167]
    ds_read_b128 v[120:123], v212 offset:6144
    v_add_f32 v253, 1.0, v253
    v_mfma_f32_16x16x32_bf16 v[168:171], v[140:143], a[64:67], v[168:171]
    buffer_load_dwordx4 v16, s[36:39], s73 offen offset:3072 sc1 lds
    v_mfma_f32_16x16x32_bf16 v[172:175], v[140:143], a[68:71], v[172:175]
    ds_read_b128 v[124:127], v212 offset:7168
    s_waitcnt lgkmcnt(4)
    v_mfma_f32_16x16x32_bf16 v[144:147], v[96:99], a[72:75], v[144:147]
    s_add_u32 m0, s65, 24576
    v_mfma_f32_16x16x32_bf16 v[148:151], v[96:99], a[76:79], v[148:151]
    ds_read_b128 v[128:131], v212 offset:45056
    s_add_u32 s73, s82, s90
    v_mfma_f32_16x16x32_bf16 v[152:155], v[100:103], a[72:75], v[152:155]
    buffer_load_dwordx4 v26, s[28:31], s73 offen offset:0 lds
    v_mfma_f32_16x16x32_bf16 v[156:159], v[100:103], a[76:79], v[156:159]
    ds_read_b128 v[132:135], v212 offset:46080
    s_waitcnt vmcnt(13)
    v_mfma_f32_16x16x32_bf16 v[160:163], v[104:107], a[72:75], v[160:163]
    s_barrier
    v_mfma_f32_16x16x32_bf16 v[164:167], v[104:107], a[76:79], v[164:167]
    ds_read_b128 v[136:139], v212 offset:47104
    v_mfma_f32_16x16x32_bf16 v[168:171], v[108:111], a[72:75], v[168:171]
    buffer_load_dwordx4 v27, s[28:31], s73 offen offset:1024 lds
    v_mfma_f32_16x16x32_bf16 v[172:175], v[108:111], a[76:79], v[172:175]
    ds_read_b128 v[140:143], v212 offset:48128
    s_waitcnt lgkmcnt(4)
    v_mfma_f32_16x16x32_bf16 v[144:147], v[112:115], a[80:83], v[144:147]
    v_exp_f32 v254, v254
    v_mfma_f32_16x16x32_bf16 v[148:151], v[112:115], a[84:87], v[148:151]
    ds_read_b128 v[96:99], v211 offset:8192
    v_add_f32 v254, 1.0, v254
    v_mfma_f32_16x16x32_bf16 v[152:155], v[116:119], a[80:83], v[152:155]
    buffer_load_dwordx4 v28, s[28:31], s73 offen offset:2048 lds
    v_mfma_f32_16x16x32_bf16 v[156:159], v[116:119], a[84:87], v[156:159]
    ds_read_b128 v[100:103], v211 offset:9216
    v_mfma_f32_16x16x32_bf16 v[160:163], v[120:123], a[80:83], v[160:163]
    v_exp_f32 v255, v255
    v_mfma_f32_16x16x32_bf16 v[164:167], v[120:123], a[84:87], v[164:167]
    ds_read_b128 v[104:107], v211 offset:10240
    v_add_f32 v255, 1.0, v255
    v_mfma_f32_16x16x32_bf16 v[168:171], v[124:127], a[80:83], v[168:171]
    v_rcp_f32 v248, v248
    v_mfma_f32_16x16x32_bf16 v[172:175], v[124:127], a[84:87], v[172:175]
    ds_read_b128 v[108:111], v211 offset:11264
    s_waitcnt lgkmcnt(4)
    v_mfma_f32_16x16x32_bf16 v[144:147], v[128:131], a[88:91], v[144:147]
    v_rcp_f32 v249, v249
    v_mfma_f32_16x16x32_bf16 v[148:151], v[128:131], a[92:95], v[148:151]
    ds_read_b128 v[112:115], v211 offset:49152
    v_mul_f32 v72, v72, v248
    v_mfma_f32_16x16x32_bf16 v[152:155], v[132:135], a[88:91], v[152:155]
    buffer_load_dwordx4 v29, s[28:31], s73 offen offset:3072 lds
    v_mfma_f32_16x16x32_bf16 v[156:159], v[132:135], a[92:95], v[156:159]
    ds_read_b128 v[116:119], v211 offset:50176
    v_mul_f32 v73, v73, v249
    v_mfma_f32_16x16x32_bf16 v[160:163], v[136:139], a[88:91], v[160:163]
    s_add_u32 m0, s65, 0
    buffer_load_dword v220, v219, s[36:39], s23 offen sc1
    v_mfma_f32_16x16x32_bf16 v[164:167], v[136:139], a[92:95], v[164:167]
    ds_read_b128 v[120:123], v211 offset:51200
    s_add_u32 s73, s94, s99
    v_mfma_f32_16x16x32_bf16 v[168:171], v[140:143], a[88:91], v[168:171]
    buffer_load_dwordx4 v16, s[36:39], s73 offen offset:0 sc1 lds
    v_mfma_f32_16x16x32_bf16 v[172:175], v[140:143], a[92:95], v[172:175]
    ds_read_b128 v[124:127], v211 offset:52224
    s_waitcnt lgkmcnt(4)
    s_waitcnt vmcnt(10)
    v_mfma_f32_16x16x32_bf16 v[144:147], v[96:99], a[96:99], v[144:147]
    ds_read_b128 a[192:195], v14 offset:20480
    v_mul_f32 v248, v80, v80
    v_mfma_f32_16x16x32_bf16 v[148:151], v[96:99], a[100:103], v[148:151]
    ds_read_b128 v[128:131], v212 offset:8192
    v_mul_f32 v249, v81, v81
    v_mfma_f32_16x16x32_bf16 v[152:155], v[100:103], a[96:99], v[152:155]
    ds_read_b128 a[196:199], v14 offset:22528
    buffer_load_dwordx4 v16, s[36:39], s73 offen offset:1024 sc1 lds
    v_mfma_f32_16x16x32_bf16 v[156:159], v[100:103], a[100:103], v[156:159]
    ds_read_b128 v[132:135], v212 offset:9216
    v_fma_f32 v248, v248, v22, v20
    v_mfma_f32_16x16x32_bf16 v[160:163], v[104:107], a[96:99], v[160:163]
    ds_read_b128 a[200:203], v15 offset:20480
    v_fma_f32 v249, v249, v22, v20
    v_mfma_f32_16x16x32_bf16 v[164:167], v[104:107], a[100:103], v[164:167]
    ds_read_b128 v[136:139], v212 offset:10240
    v_mul_f32 v248, v248, v80
    v_mfma_f32_16x16x32_bf16 v[168:171], v[108:111], a[96:99], v[168:171]
    ds_read_b128 a[204:207], v15 offset:22528
    buffer_load_dwordx4 v16, s[36:39], s73 offen offset:2048 sc1 lds
    v_mfma_f32_16x16x32_bf16 v[172:175], v[108:111], a[100:103], v[172:175]
    ds_read_b128 v[140:143], v212 offset:11264
    s_waitcnt lgkmcnt(8)
    v_mfma_f32_16x16x32_bf16 v[144:147], v[112:115], a[104:107], v[144:147]
    v_rcp_f32 v250, v250
    v_mfma_f32_16x16x32_bf16 v[148:151], v[112:115], a[108:111], v[148:151]
    ds_read_b128 v[96:99], v212 offset:49152
    v_mul_f32 v74, v74, v250
    v_mfma_f32_16x16x32_bf16 v[152:155], v[116:119], a[104:107], v[152:155]
    buffer_load_dwordx4 v16, s[36:39], s73 offen offset:3072 sc1 lds
    v_mfma_f32_16x16x32_bf16 v[156:159], v[116:119], a[108:111], v[156:159]
    ds_read_b128 v[100:103], v212 offset:50176
    v_mfma_f32_16x16x32_bf16 v[160:163], v[120:123], a[104:107], v[160:163]
    s_add_u32 m0, s65, 28672
    s_barrier
    v_mfma_f32_16x16x32_bf16 v[164:167], v[120:123], a[108:111], v[164:167]
    ds_read_b128 v[104:107], v212 offset:51200
    s_add_u32 s73, s82, s91
    v_mfma_f32_16x16x32_bf16 v[168:171], v[124:127], a[104:107], v[168:171]
    buffer_load_dwordx4 v26, s[28:31], s73 offen offset:0 lds
    v_mfma_f32_16x16x32_bf16 v[172:175], v[124:127], a[108:111], v[172:175]
    ds_read_b128 v[108:111], v212 offset:52224
    s_waitcnt lgkmcnt(4)
    v_mfma_f32_16x16x32_bf16 v[144:147], v[128:131], a[112:115], v[144:147]
    v_rcp_f32 v251, v251
    v_mfma_f32_16x16x32_bf16 v[148:151], v[128:131], a[116:119], v[148:151]
    ds_read_b128 v[112:115], v211 offset:12288
    v_mul_f32 v75, v75, v251
    v_mfma_f32_16x16x32_bf16 v[152:155], v[132:135], a[112:115], v[152:155]
    buffer_load_dwordx4 v27, s[28:31], s73 offen offset:1024 lds
    v_mfma_f32_16x16x32_bf16 v[156:159], v[132:135], a[116:119], v[156:159]
    ds_read_b128 v[116:119], v211 offset:13312
    v_mul_f32 v250, v82, v82
    v_mfma_f32_16x16x32_bf16 v[160:163], v[136:139], a[112:115], v[160:163]
    v_rcp_f32 v252, v252
    v_mfma_f32_16x16x32_bf16 v[164:167], v[136:139], a[116:119], v[164:167]
    ds_read_b128 v[120:123], v211 offset:14336
    v_mul_f32 v76, v76, v252
    v_mfma_f32_16x16x32_bf16 v[168:171], v[140:143], a[112:115], v[168:171]
    buffer_load_dwordx4 v28, s[28:31], s73 offen offset:2048 lds
    v_mfma_f32_16x16x32_bf16 v[172:175], v[140:143], a[116:119], v[172:175]
    ds_read_b128 v[124:127], v211 offset:15360
    s_waitcnt lgkmcnt(4)
    v_mfma_f32_16x16x32_bf16 v[144:147], v[96:99], a[120:123], v[144:147]
    v_rcp_f32 v253, v253
    v_mfma_f32_16x16x32_bf16 v[148:151], v[96:99], a[124:127], v[148:151]
    ds_read_b128 v[128:131], v211 offset:53248
    v_mul_f32 v77, v77, v253
    v_mfma_f32_16x16x32_bf16 v[152:155], v[100:103], a[120:123], v[152:155]
    buffer_load_dwordx4 v29, s[28:31], s73 offen offset:3072 lds
    v_mfma_f32_16x16x32_bf16 v[156:159], v[100:103], a[124:127], v[156:159]
    ds_read_b128 v[132:135], v211 offset:54272
    v_mul_f32 v251, v83, v83
    v_mfma_f32_16x16x32_bf16 v[160:163], v[104:107], a[120:123], v[160:163]
    v_rcp_f32 v254, v254
    v_mfma_f32_16x16x32_bf16 v[164:167], v[104:107], a[124:127], v[164:167]
    ds_read_b128 v[136:139], v211 offset:55296
    v_mul_f32 v78, v78, v254
    v_mfma_f32_16x16x32_bf16 v[168:171], v[108:111], a[120:123], v[168:171]
    v_rcp_f32 v255, v255
    v_mfma_f32_16x16x32_bf16 v[172:175], v[108:111], a[124:127], v[172:175]
    ds_read_b128 v[140:143], v211 offset:56320
    s_waitcnt lgkmcnt(4)
    v_mfma_f32_16x16x32_bf16 v[144:147], v[112:115], a[128:131], v[144:147]
    s_add_u32 m0, s65, 4096
    v_mul_f32 v79, v79, v255
    v_mfma_f32_16x16x32_bf16 v[148:151], v[112:115], a[132:135], v[148:151]
    ds_read_b128 v[96:99], v212 offset:12288
    s_add_u32 s73, s94, s100
    v_mfma_f32_16x16x32_bf16 v[152:155], v[116:119], a[128:131], v[152:155]
    buffer_load_dwordx4 v16, s[36:39], s73 offen offset:0 sc1 lds
    v_mfma_f32_16x16x32_bf16 v[156:159], v[116:119], a[132:135], v[156:159]
    ds_read_b128 v[100:103], v212 offset:13312
    v_mul_f32 v252, v84, v84
    v_mfma_f32_16x16x32_bf16 v[160:163], v[120:123], a[128:131], v[160:163]
    v_exp_f32 v248, v248
    v_mfma_f32_16x16x32_bf16 v[164:167], v[120:123], a[132:135], v[164:167]
    ds_read_b128 v[104:107], v212 offset:14336
    v_mul_f32 v253, v85, v85
    v_mfma_f32_16x16x32_bf16 v[168:171], v[124:127], a[128:131], v[168:171]
    buffer_load_dwordx4 v16, s[36:39], s73 offen offset:1024 sc1 lds
    v_mfma_f32_16x16x32_bf16 v[172:175], v[124:127], a[132:135], v[172:175]
    ds_read_b128 v[108:111], v212 offset:15360
    s_waitcnt lgkmcnt(4)
    s_waitcnt vmcnt(11)
    v_mfma_f32_16x16x32_bf16 v[144:147], v[128:131], a[136:139], v[144:147]
    ds_read_b128 a[208:211], v14 offset:24576
    s_waitcnt vmcnt(10)
    v_cmp_ne_u32 vcc, s15, v220
    s_nop 0
    s_cmp_lg_u64 vcc, 0
    s_cbranch_scc1 L_slow_5
L_back_6:
    v_mfma_f32_16x16x32_bf16 v[148:151], v[128:131], a[140:143], v[148:151]
    ds_read_b128 v[112:115], v212 offset:53248
    v_mul_f32 v254, v86, v86
    v_mfma_f32_16x16x32_bf16 v[152:155], v[132:135], a[136:139], v[152:155]
    ds_read_b128 a[212:215], v14 offset:26624
    buffer_load_dwordx4 v16, s[36:39], s73 offen offset:2048 sc1 lds
    v_mfma_f32_16x16x32_bf16 v[156:159], v[132:135], a[140:143], v[156:159]
    ds_read_b128 v[116:119], v212 offset:54272
    v_mfma_f32_16x16x32_bf16 v[160:163], v[136:139], a[136:139], v[160:163]
    ds_read_b128 a[216:219], v15 offset:24576
    s_barrier
    v_mfma_f32_16x16x32_bf16 v[164:167], v[136:139], a[140:143], v[164:167]
    ds_read_b128 v[120:123], v212 offset:55296
    v_mul_f32 v255, v87, v87
    v_mfma_f32_16x16x32_bf16 v[168:171], v[140:143], a[136:139], v[168:171]
    ds_read_b128 a[220:223], v15 offset:26624
    buffer_load_dwordx4 v16, s[36:39], s73 offen offset:3072 sc1 lds
    v_mfma_f32_16x16x32_bf16 v[172:175], v[140:143], a[140:143], v[172:175]
    ds_read_b128 v[124:127], v212 offset:56320
    s_waitcnt lgkmcnt(8)
    v_mfma_f32_16x16x32_bf16 v[144:147], v[96:99], a[144:147], v[144:147]
    s_add_u32 m0, s65, 8192
    v_fma_f32 v250, v250, v22, v20
    v_mfma_f32_16x16x32_bf16 v[148:151], v[96:99], a[148:151], v[148:151]
    ds_read_b128 v[128:131], v211 offset:16384
    s_add_u32 s73, s95, s97
    v_mfma_f32_16x16x32_bf16 v[152:155], v[100:103], a[144:147], v[152:155]
    buffer_load_dwordx4 v16, s[36:39], s73 offen offset:0 sc1 lds
    v_mfma_f32_16x16x32_bf16 v[156:159], v[100:103], a[148:151], v[156:159]
    ds_read_b128 v[132:135], v211 offset:17408
    v_fma_f32 v251, v251, v22, v20
    v_mfma_f32_16x16x32_bf16 v[160:163], v[104:107], a[144:147], v[160:163]
    v_fma_f32 v252, v252, v22, v20
    v_fma_f32 v253, v253, v22, v20
    v_mfma_f32_16x16x32_bf16 v[164:167], v[104:107], a[148:151], v[164:167]
    ds_read_b128 v[136:139], v211 offset:18432
    v_fma_f32 v254, v254, v22, v20
    v_mfma_f32_16x16x32_bf16 v[168:171], v[108:111], a[144:147], v[168:171]
    buffer_load_dwordx4 v16, s[36:39], s73 offen offset:1024 sc1 lds
    v_mfma_f32_16x16x32_bf16 v[172:175], v[108:111], a[148:151], v[172:175]
    ds_read_b128 v[140:143], v211 offset:19456
    s_waitcnt lgkmcnt(4)
    v_mfma_f32_16x16x32_bf16 v[144:147], v[112:115], a[152:155], v[144:147]
    v_fma_f32 v255, v255, v22, v20
    v_mul_f32 v249, v249, v81
    v_mfma_f32_16x16x32_bf16 v[148:151], v[112:115], a[156:159], v[148:151]
    ds_read_b128 v[96:99], v211 offset:57344
    v_mul_f32 v250, v250, v82
    v_mfma_f32_16x16x32_bf16 v[152:155], v[116:119], a[152:155], v[152:155]
    buffer_load_dwordx4 v16, s[36:39], s73 offen offset:2048 sc1 lds
    v_mfma_f32_16x16x32_bf16 v[156:159], v[116:119], a[156:159], v[156:159]
    ds_read_b128 v[100:103], v211 offset:58368
    v_mul_f32 v251, v251, v83
    v_mfma_f32_16x16x32_bf16 v[160:163], v[120:123], a[152:155], v[160:163]
    v_exp_f32 v249, v249
    v_mfma_f32_16x16x32_bf16 v[164:167], v[120:123], a[156:159], v[164:167]
    ds_read_b128 v[104:107], v211 offset:59392
    v_mul_f32 v252, v252, v84
    v_mfma_f32_16x16x32_bf16 v[168:171], v[124:127], a[152:155], v[168:171]
    buffer_load_dwordx4 v16, s[36:39], s73 offen offset:3072 sc1 lds
    v_mfma_f32_16x16x32_bf16 v[172:175], v[124:127], a[156:159], v[172:175]
    ds_read_b128 v[108:111], v211 offset:60416
    s_waitcnt lgkmcnt(4)
    v_mfma_f32_16x16x32_bf16 v[144:147], v[128:131], a[160:163], v[144:147]
    s_add_u32 m0, s65, 32768
    v_mfma_f32_16x16x32_bf16 v[148:151], v[128:131], a[164:167], v[148:151]
    ds_read_b128 v[112:115], v212 offset:16384
    s_add_u32 s73, s82, s92
    v_mfma_f32_16x16x32_bf16 v[152:155], v[132:135], a[160:163], v[152:155]
    buffer_load_dwordx4 v26, s[28:31], s73 offen offset:0 lds
    v_mfma_f32_16x16x32_bf16 v[156:159], v[132:135], a[164:167], v[156:159]
    ds_read_b128 v[116:119], v212 offset:17408
    v_mul_f32 v253, v253, v85
    v_mfma_f32_16x16x32_bf16 v[160:163], v[136:139], a[160:163], v[160:163]
    v_exp_f32 v250, v250
    v_mfma_f32_16x16x32_bf16 v[164:167], v[136:139], a[164:167], v[164:167]
    ds_read_b128 v[120:123], v212 offset:18432
    v_mul_f32 v254, v254, v86
    v_mfma_f32_16x16x32_bf16 v[168:171], v[140:143], a[160:163], v[168:171]
    v_exp_f32 v251, v251
    v_mfma_f32_16x16x32_bf16 v[172:175], v[140:143], a[164:167], v[172:175]
    ds_read_b128 v[124:127], v212 offset:19456
    s_waitcnt lgkmcnt(4)
    s_waitcnt vmcnt(9)
    v_mfma_f32_16x16x32_bf16 v[144:147], v[96:99], a[168:171], v[144:147]
    ds_read_b128 a[224:227], v14 offset:28672
    v_mul_f32 v255, v255, v87
    v_mfma_f32_16x16x32_bf16 v[148:151], v[96:99], a[172:175], v[148:151]
    ds_read_b128 v[128:131], v212 offset:57344
    v_add_f32 v248, 1.0, v248
    v_mfma_f32_16x16x32_bf16 v[152:155], v[100:103], a[168:171], v[152:155]
    ds_read_b128 a[228:231], v14 offset:30720
    buffer_load_dwordx4 v27, s[28:31], s73 offen offset:1024 lds
    v_mfma_f32_16x16x32_bf16 v[156:159], v[100:103], a[172:175], v[156:159]
    ds_read_b128 v[132:135], v212 offset:58368
    v_mfma_f32_16x16x32_bf16 v[160:163], v[104:107], a[168:171], v[160:163]
    ds_read_b128 a[232:235], v15 offset:28672
    s_barrier
    v_mfma_f32_16x16x32_bf16 v[164:167], v[104:107], a[172:175], v[164:167]
    ds_read_b128 v[136:139], v212 offset:59392
    v_add_f32 v249, 1.0, v249
    v_mfma_f32_16x16x32_bf16 v[168:171], v[108:111], a[168:171], v[168:171]
    ds_read_b128 a[236:239], v15 offset:30720
    buffer_load_dwordx4 v28, s[28:31], s73 offen offset:2048 lds
    v_mfma_f32_16x16x32_bf16 v[172:175], v[108:111], a[172:175], v[172:175]
    ds_read_b128 v[140:143], v212 offset:60416
    s_waitcnt lgkmcnt(8)
    v_mfma_f32_16x16x32_bf16 v[144:147], v[112:115], a[176:179], v[144:147]
    v_exp_f32 v252, v252
    v_mfma_f32_16x16x32_bf16 v[148:151], v[112:115], a[180:183], v[148:151]
    ds_read_b128 v[96:99], v211 offset:0
    v_add_f32 v250, 1.0, v250
    v_mfma_f32_16x16x32_bf16 v[152:155], v[116:119], a[176:179], v[152:155]
    buffer_load_dwordx4 v29, s[28:31], s73 offen offset:3072 lds
    v_mfma_f32_16x16x32_bf16 v[156:159], v[116:119], a[180:183], v[156:159]
    ds_read_b128 v[100:103], v211 offset:1024
    v_add_f32 v251, 1.0, v251
    v_mfma_f32_16x16x32_bf16 v[160:163], v[120:123], a[176:179], v[160:163]
    s_add_u32 m0, s65, 12288
    v_add_f32 v252, 1.0, v252
    v_mfma_f32_16x16x32_bf16 v[164:167], v[120:123], a[180:183], v[164:167]
    ds_read_b128 v[104:107], v211 offset:2048
    s_add_u32 s73, s95, s98
    v_mfma_f32_16x16x32_bf16 v[168:171], v[124:127], a[176:179], v[168:171]
    buffer_load_dwordx4 v16, s[36:39], s73 offen offset:0 sc1 lds
    v_mfma_f32_16x16x32_bf16 v[172:175], v[124:127], a[180:183], v[172:175]
    ds_read_b128 v[108:111], v211 offset:3072
    s_waitcnt lgkmcnt(4)
    v_mfma_f32_16x16x32_bf16 v[144:147], v[128:131], a[184:187], v[144:147]
    v_exp_f32 v253, v253
    v_mfma_f32_16x16x32_bf16 v[148:151], v[128:131], a[188:191], v[148:151]
    ds_read_b128 v[112:115], v211 offset:40960
    v_add_f32 v253, 1.0, v253
    v_mfma_f32_16x16x32_bf16 v[152:155], v[132:135], a[184:187], v[152:155]
L_pad4:
    s_cbranch_execz L_hop1
    buffer_load_dwordx4 v16, s[36:39], s73 offen offset:1024 sc1 lds
    v_mfma_f32_16x16x32_bf16 v[156:159], v[132:135], a[188:191], v[156:159]
    ds_read_b128 v[116:119], v211 offset:41984
    v_mfma_f32_16x16x32_bf16 v[160:163], v[136:139], a[184:187], v[160:163]
    v_exp_f32 v254, v254
    v_mfma_f32_16x16x32_bf16 v[164:167], v[136:139], a[188:191], v[164:167]
    ds_read_b128 v[120:123], v211 offset:43008
    v_add_f32 v254, 1.0, v254
    v_mfma_f32_16x16x32_bf16 v[168:171], v[140:143], a[184:187], v[168:171]
    buffer_load_dwordx4 v16, s[36:39], s73 offen offset:2048 sc1 lds
    v_mfma_f32_16x16x32_bf16 v[172:175], v[140:143], a[188:191], v[172:175]
    ds_read_b128 v[124:127], v211 offset:44032
    s_waitcnt lgkmcnt(4)
    v_mfma_f32_16x16x32_bf16 v[144:147], v[96:99], a[192:195], v[144:147]
    v_exp_f32 v255, v255
    v_mfma_f32_16x16x32_bf16 v[148:151], v[96:99], a[196:199], v[148:151]
    ds_read_b128 v[128:131], v212 offset:0
    v_add_f32 v255, 1.0, v255
    v_mfma_f32_16x16x32_bf16 v[152:155], v[100:103], a[192:195], v[152:155]
    buffer_load_dwordx4 v16, s[36:39], s73 offen offset:3072 sc1 lds
    v_mfma_f32_16x16x32_bf16 v[156:159], v[100:103], a[196:199], v[156:159]
    ds_read_b128 v[132:135], v212 offset:1024
    v_mfma_f32_16x16x32_bf16 v[160:163], v[104:107], a[192:195], v[160:163]
    s_add_u32 m0, s65, 20480
    v_mfma_f32_16x16x32_bf16 v[164:167], v[104:107], a[196:199], v[164:167]
    ds_read_b128 v[136:139], v212 offset:2048
    s_mul_i32 s73, s74, 896
    v_mfma_f32_16x16x32_bf16 v[168:171], v[108:111], a[192:195], v[168:171]
    buffer_load_dwordx4 v214, s[32:35], s73 offen offset:0 lds
    v_mfma_f32_16x16x32_bf16 v[172:175], v[108:111], a[196:199], v[172:175]
    ds_read_b128 v[140:143], v212 offset:3072
    s_waitcnt lgkmcnt(4)
    v_mfma_f32_16x16x32_bf16 v[144:147], v[112:115], a[200:203], v[144:147]
    v_rcp_f32 v248, v248
    v_mfma_f32_16x16x32_bf16 v[148:151], v[112:115], a[204:207], v[148:151]
    ds_read_b128 v[96:99], v212 offset:40960
    v_mul_f32 v80, v80, v248
    v_mfma_f32_16x16x32_bf16 v[152:155], v[116:119], a[200:203], v[152:155]
    buffer_load_dwordx4 v215, s[32:35], s73 offen offset:1024 lds
    v_mfma_f32_16x16x32_bf16 v[156:159], v[116:119], a[204:207], v[156:159]
    ds_read_b128 v[100:103], v212 offset:41984
    s_waitcnt vmcnt(14)
    v_mfma_f32_16x16x32_bf16 v[160:163], v[120:123], a[200:203], v[160:163]
    s_barrier
    v_mul_f32 v248, v88, v88
    v_mfma_f32_16x16x32_bf16 v[164:167], v[120:123], a[204:207], v[164:167]
    ds_read_b128 v[104:107], v212 offset:43008
    v_fma_f32 v248, v248, v22, v20
    v_mfma_f32_16x16x32_bf16 v[168:171], v[124:127], a[200:203], v[168:171]
    v_rcp_f32 v249, v249
    v_mfma_f32_16x16x32_bf16 v[172:175], v[124:127], a[204:207], v[172:175]
    ds_read_b128 v[108:111], v212 offset:44032
    s_waitcnt lgkmcnt(4)
    v_mfma_f32_16x16x32_bf16 v[144:147], v[128:131], a[208:211], v[144:147]
    v_rcp_f32 v250, v250
    v_mfma_f32_16x16x32_bf16 v[148:151], v[128:131], a[212:215], v[148:151]
    ds_read_b128 v[112:115], v211 offset:4096
    v_mul_f32 v81, v81, v249
    v_mfma_f32_16x16x32_bf16 v[152:155], v[132:135], a[208:211], v[152:155]
    buffer_load_dwordx4 v216, s[32:35], s73 offen offset:2048 lds
    v_mfma_f32_16x16x32_bf16 v[156:159], v[132:135], a[212:215], v[156:159]
    ds_read_b128 v[116:119], v211 offset:5120
    v_mul_f32 v82, v82, v250
    v_mfma_f32_16x16x32_bf16 v[160:163], v[136:139], a[208:211], v[160:163]
    v_rcp_f32 v251, v251
    v_mfma_f32_16x16x32_bf16 v[164:167], v[136:139], a[212:215], v[164:167]
    ds_read_b128 v[120:123], v211 offset:6144
    v_mul_f32 v83, v83, v251
    v_mfma_f32_16x16x32_bf16 v[168:171], v[140:143], a[208:211], v[168:171]
    buffer_load_dwordx4 v217, s[32:35], s73 offen offset:3072 lds
    v_mfma_f32_16x16x32_bf16 v[172:175], v[140:143], a[212:215], v[172:175]
    ds_read_b128 v[124:127], v211 offset:7168
    s_waitcnt lgkmcnt(4)
    v_mfma_f32_16x16x32_bf16 v[144:147], v[96:99], a[216:219], v[144:147]
    s_add_u32 m0, s65, 16384
    v_mul_f32 v249, v89, v89
    v_mfma_f32_16x16x32_bf16 v[148:151], v[96:99], a[220:223], v[148:151]
    ds_read_b128 v[128:131], v211 offset:45056
    s_add_u32 s73, s95, s99
    v_mfma_f32_16x16x32_bf16 v[152:155], v[100:103], a[216:219], v[152:155]
    buffer_load_dwordx4 v16, s[36:39], s73 offen offset:0 sc1 lds
    v_mfma_f32_16x16x32_bf16 v[156:159], v[100:103], a[220:223], v[156:159]
    ds_read_b128 v[132:135], v211 offset:46080
    v_mul_f32 v250, v90, v90
    v_mfma_f32_16x16x32_bf16 v[160:163], v[104:107], a[216:219], v[160:163]
    v_rcp_f32 v252, v252
    v_mfma_f32_16x16x32_bf16 v[164:167], v[104:107], a[220:223], v[164:167]
    ds_read_b128 v[136:139], v211 offset:47104
    v_mul_f32 v84, v84, v252
    v_mfma_f32_16x16x32_bf16 v[168:171], v[108:111], a[216:219], v[168:171]
    buffer_load_dwordx4 v16, s[36:39], s73 offen offset:1024 sc1 lds
    v_mfma_f32_16x16x32_bf16 v[172:175], v[108:111], a[220:223], v[172:175]
    ds_read_b128 v[140:143], v211 offset:48128
    s_waitcnt lgkmcnt(4)
    s_waitcnt vmcnt(10)
    v_mfma_f32_16x16x32_bf16 v[144:147], v[112:115], a[224:227], v[144:147]
    ds_read_b128 a[240:243], v14 offset:32768
    v_mul_f32 v251, v91, v91
    v_mfma_f32_16x16x32_bf16 v[148:151], v[112:115], a[228:231], v[148:151]
    ds_read_b128 v[96:99], v212 offset:4096
    v_mul_f32 v252, v92, v92
    v_mfma_f32_16x16x32_bf16 v[152:155], v[116:119], a[224:227], v[152:155]
    ds_read_b128 a[244:247], v14 offset:34816
    buffer_load_dwordx4 v16, s[36:39], s73 offen offset:2048 sc1 lds
    v_mfma_f32_16x16x32_bf16 v[156:159], v[116:119], a[228:231], v[156:159]
    ds_read_b128 v[100:103], v212 offset:5120
    v_fma_f32 v249, v249, v22, v20
    v_mfma_f32_16x16x32_bf16 v[160:163], v[120:123], a[224:227], v[160:163]
    ds_read_b128 a[248:251], v15 offset:32768
    v_fma_f32 v250, v250, v22, v20
    v_mfma_f32_16x16x32_bf16 v[164:167], v[120:123], a[228:231], v[164:167]
    ds_read_b128 v[104:107], v212 offset:6144
    v_fma_f32 v251, v251, v22, v20
    v_mfma_f32_16x16x32_bf16 v[168:171], v[124:127], a[224:227], v[168:171]
    ds_read_b128 a[252:255], v15 offset:34816
    buffer_load_dwordx4 v16, s[36:39], s73 offen offset:3072 sc1 lds
    v_mfma_f32_16x16x32_bf16 v[172:175], v[124:127], a[228:231], v[172:175]
    ds_read_b128 v[108:111], v212 offset:7168
    s_waitcnt lgkmcnt(8)
    v_mfma_f32_16x16x32_bf16 v[144:147], v[128:131], a[232:235], v[144:147]
    s_add_u32 m0, s65, 24576
    v_mfma_f32_16x16x32_bf16 v[148:151], v[128:131], a[236:239], v[148:151]
    ds_read_b128 v[112:115], v212 offset:45056
    s_mul_i32 s73, s75, 896
    v_mfma_f32_16x16x32_bf16 v[152:155], v[132:135], a[232:235], v[152:155]
    buffer_load_dwordx4 v214, s[32:35], s73 offen offset:0 lds
    v_mfma_f32_16x16x32_bf16 v[156:159], v[132:135], a[236:239], v[156:159]
    ds_read_b128 v[116:119], v212 offset:46080
    v_mfma_f32_16x16x32_bf16 v[160:163], v[136:139], a[232:235], v[160:163]
    s_barrier
    v_fma_f32 v252, v252, v22, v20
    v_mfma_f32_16x16x32_bf16 v[164:167], v[136:139], a[236:239], v[164:167]
    ds_read_b128 v[120:123], v212 offset:47104
    v_mul_f32 v248, v248, v88
    v_mfma_f32_16x16x32_bf16 v[168:171], v[140:143], a[232:235], v[168:171]
    buffer_load_dwordx4 v215, s[32:35], s73 offen offset:1024 lds
    v_mfma_f32_16x16x32_bf16 v[172:175], v[140:143], a[236:239], v[172:175]
    ds_read_b128 v[124:127], v212 offset:48128
    s_waitcnt lgkmcnt(4)
    v_mfma_f32_16x16x32_bf16 v[144:147], v[96:99], a[240:243], v[144:147]
    v_rcp_f32 v253, v253
    v_mfma_f32_16x16x32_bf16 v[148:151], v[96:99], a[244:247], v[148:151]
    ds_read_b128 v[128:131], v211 offset:8192
    v_mul_f32 v85, v85, v253
    v_mfma_f32_16x16x32_bf16 v[152:155], v[100:103], a[240:243], v[152:155]
    buffer_load_dwordx4 v216, s[32:35], s73 offen offset:2048 lds
    v_mfma_f32_16x16x32_bf16 v[156:159], v[100:103], a[244:247], v[156:159]
    ds_read_b128 v[132:135], v211 offset:9216
    v_mul_f32 v253, v93, v93
    v_mfma_f32_16x16x32_bf16 v[160:163], v[104:107], a[240:243], v[160:163]
    v_rcp_f32 v254, v254
    v_mfma_f32_16x16x32_bf16 v[164:167], v[104:107], a[244:247], v[164:167]
    ds_read_b128 v[136:139], v211 offset:10240
    v_mul_f32 v86, v86, v254
    v_mfma_f32_16x16x32_bf16 v[168:171], v[108:111], a[240:243], v[168:171]
    v_rcp_f32 v255, v255
    v_mfma_f32_16x16x32_bf16 v[172:175], v[108:111], a[244:247], v[172:175]
    ds_read_b128 v[140:143], v211 offset:11264
    s_waitcnt lgkmcnt(4)
    v_mfma_f32_16x16x32_bf16 v[144:147], v[112:115], a[248:251], v[144:147]
    v_exp_f32 v248, v248
    v_mfma_f32_16x16x32_bf16 v[148:151], v[112:115], a[252:255], v[148:151]
    ds_read_b128 v[96:99], v211 offset:49152
    v_mul_f32 v87, v87, v255
    v_mfma_f32_16x16x32_bf16 v[152:155], v[116:119], a[248:251], v[152:155]
    buffer_load_dwordx4 v217, s[32:35], s73 offen offset:3072 lds
    v_mfma_f32_16x16x32_bf16 v[156:159], v[116:119], a[252:255], v[156:159]
    ds_read_b128 v[100:103], v211 offset:50176
    v_mul_f32 v254, v94, v94
    v_mfma_f32_16x16x32_bf16 v[160:163], v[120:123], a[248:251], v[160:163]
    v_mul_f32 v255, v95, v95
    v_fma_f32 v253, v253, v22, v20
    v_mfma_f32_16x16x32_bf16 v[164:167], v[120:123], a[252:255], v[164:167]
    ds_read_b128 v[104:107], v211 offset:51200
    v_fma_f32 v254, v254, v22, v20
    v_mfma_f32_16x16x32_bf16 v[168:171], v[124:127], a[248:251], v[168:171]
    v_fma_f32 v255, v255, v22, v20
    v_mul_f32 v249, v249, v89
    v_mfma_f32_16x16x32_bf16 v[172:175], v[124:127], a[252:255], v[172:175]
    ds_read_b128 v[108:111], v211 offset:52224
    s_waitcnt lgkmcnt(4)
    v_mfma_f32_16x16x32_bf16 v[32:35], v[128:131], a[0:3], v[56:59]
    s_add_u32 m0, s65, 0
    v_mul_f32 v250, v250, v90
    v_mfma_f32_16x16x32_bf16 v[36:39], v[128:131], a[4:7], v[60:63]
    ds_read_b128 v[112:115], v212 offset:8192
    s_add_u32 s73, s95, s100
    v_mfma_f32_16x16x32_bf16 v[40:43], v[132:135], a[0:3], v[56:59]
    buffer_load_dwordx4 v16, s[36:39], s73 offen offset:0 sc1 lds
    v_mfma_f32_16x16x32_bf16 v[44:47], v[132:135], a[4:7], v[60:63]
    ds_read_b128 v[116:119], v212 offset:9216
    v_mul_f32 v251, v251, v91
    v_mfma_f32_16x16x32_bf16 v[48:51], v[136:139], a[0:3], v[56:59]
    v_exp_f32 v249, v249
    v_mfma_f32_16x16x32_bf16 v[52:55], v[136:139], a[4:7], v[60:63]
    ds_read_b128 v[120:123], v212 offset:10240
    v_mul_f32 v252, v252, v92
    v_mfma_f32_16x16x32_bf16 v[56:59], v[140:143], a[0:3], v[56:59]
    v_exp_f32 v250, v250
    v_mfma_f32_16x16x32_bf16 v[60:63], v[140:143], a[4:7], v[60:63]
    ds_read_b128 v[124:127], v212 offset:11264
    s_waitcnt lgkmcnt(4)
    v_mfma_f32_16x16x32_bf16 v[32:35], v[96:99], a[8:11], v[32:35]
    v_cvt_pk_bf16_f32 v176, v144, v145
    v_cvt_pk_bf16_f32 v177, v146, v147
    v_mfma_f32_16x16x32_bf16 v[36:39], v[96:99], a[12:15], v[36:39]
    ds_read_b128 v[128:131], v212 offset:49152
    v_cvt_pk_bf16_f32 v178, v148, v149
    v_mfma_f32_16x16x32_bf16 v[40:43], v[100:103], a[8:11], v[40:43]
    buffer_load_dwordx4 v16, s[36:39], s73 offen offset:1024 sc1 lds
    v_bfi_b32 v179, s53, v30, v150
    v_mfma_f32_16x16x32_bf16 v[44:47], v[100:103], a[12:15], v[44:47]
    ds_read_b128 v[132:135], v212 offset:50176
    s_waitcnt vmcnt(14)
    v_mfma_f32_16x16x32_bf16 v[48:51], v[104:107], a[8:11], v[48:51]
    s_barrier
    v_mul_f32 v253, v253, v93
    v_mfma_f32_16x16x32_bf16 v[52:55], v[104:107], a[12:15], v[52:55]
    ds_read_b128 v[136:139], v212 offset:51200
    v_mul_f32 v254, v254, v94
    v_mfma_f32_16x16x32_bf16 v[56:59], v[108:111], a[8:11], v[56:59]
    buffer_store_dwordx4 v[176:179], v16, s[36:39], s54 offen offset:0 sc1
    v_mfma_f32_16x16x32_bf16 v[60:63], v[108:111], a[12:15], v[60:63]
    ds_read_b128 v[140:143], v212 offset:52224
    s_waitcnt lgkmcnt(4)
    v_mfma_f32_16x16x32_bf16 v[32:35], v[112:115], a[16:19], v[32:35]
    v_exp_f32 v251, v251
    v_mfma_f32_16x16x32_bf16 v[36:39], v[112:115], a[20:23], v[36:39]
    ds_read_b128 v[96:99], v211 offset:12288
    v_mul_f32 v255, v255, v95
    v_mfma_f32_16x16x32_bf16 v[40:43], v[116:119], a[16:19], v[40:43]
    buffer_load_dwordx4 v16, s[36:39], s73 offen offset:2048 sc1 lds
    v_mfma_f32_16x16x32_bf16 v[44:47], v[116:119], a[20:23], v[44:47]
    ds_read_b128 v[100:103], v211 offset:13312
    v_add_f32 v248, 1.0, v248
    v_mfma_f32_16x16x32_bf16 v[48:51], v[120:123], a[16:19], v[48:51]
    v_exp_f32 v252, v252
    v_mfma_f32_16x16x32_bf16 v[52:55], v[120:123], a[20:23], v[52:55]
    ds_read_b128 v[104:107], v211 offset:14336
    v_add_f32 v249, 1.0, v249
    v_mfma_f32_16x16x32_bf16 v[56:59], v[124:127], a[16:19], v[56:59]
    buffer_load_dwordx4 v16, s[36:39], s73 offen offset:3072 sc1 lds
    v_mfma_f32_16x16x32_bf16 v[60:63], v[124:127], a[20:23], v[60:63]
    ds_read_b128 v[108:111], v211 offset:15360
    s_waitcnt lgkmcnt(4)
    v_mfma_f32_16x16x32_bf16 v[32:35], v[128:131], a[24:27], v[32:35]
    s_add_u32 m0, s65, 4096
    v_cvt_pk_bf16_f32 v180, v151, v152
    v_mfma_f32_16x16x32_bf16 v[36:39], v[128:131], a[28:31], v[36:39]
    ds_read_b128 v[112:115], v211 offset:53248
    s_add_u32 s73, s96, s97
    v_mfma_f32_16x16x32_bf16 v[40:43], v[132:135], a[24:27], v[40:43]
    buffer_load_dwordx4 v16, s[36:39], s73 offen offset:0 sc1 lds
    v_cvt_pk_bf16_f32 v181, v153, v154
    v_mfma_f32_16x16x32_bf16 v[44:47], v[132:135], a[28:31], v[44:47]
    ds_read_b128 v[116:119], v211 offset:54272
    v_cvt_pk_bf16_f32 v182, v155, v156
    v_mfma_f32_16x16x32_bf16 v[48:51], v[136:139], a[24:27], v[48:51]
    v_bfi_b32 v183, s53, v30, v157
    v_add_f32 v250, 1.0, v250
    v_mfma_f32_16x16x32_bf16 v[52:55], v[136:139], a[28:31], v[52:55]
    ds_read_b128 v[120:123], v211 offset:55296
    v_add_f32 v251, 1.0, v251
    v_mfma_f32_16x16x32_bf16 v[56:59], v[140:143], a[24:27], v[56:59]
    buffer_store_dwordx4 v[180:183], v16, s[36:39], s54 offen offset:1024 sc1
    v_mfma_f32_16x16x32_bf16 v[60:63], v[140:143], a[28:31], v[60:63]
    ds_read_b128 v[124:127], v211 offset:56320
    s_waitcnt lgkmcnt(4)
    v_mfma_f32_16x16x32_bf16 v[32:35], v[96:99], a[32:35], v[32:35]
    v_exp_f32 v253, v253
    v_mfma_f32_16x16x32_bf16 v[36:39], v[96:99], a[36:39], v[36:39]
    ds_read_b128 v[128:131], v212 offset:12288
    v_add_f32 v252, 1.0, v252
    v_mfma_f32_16x16x32_bf16 v[40:43], v[100:103], a[32:35], v[40:43]
    buffer_load_dwordx4 v16, s[36:39], s73 offen offset:1024 sc1 lds
    v_mfma_f32_16x16x32_bf16 v[44:47], v[100:103], a[36:39], v[44:47]
    ds_read_b128 v[132:135], v212 offset:13312
    v_add_f32 v253, 1.0, v253
    v_mfma_f32_16x16x32_bf16 v[48:51], v[104:107], a[32:35], v[48:51]
    v_exp_f32 v254, v254
    v_mfma_f32_16x16x32_bf16 v[52:55], v[104:107], a[36:39], v[52:55]
    ds_read_b128 v[136:139], v212 offset:14336
    v_add_f32 v254, 1.0, v254
    v_mfma_f32_16x16x32_bf16 v[56:59], v[108:111], a[32:35], v[56:59]
    v_exp_f32 v255, v255
    v_mfma_f32_16x16x32_bf16 v[60:63], v[108:111], a[36:39], v[60:63]
    ds_read_b128 v[140:143], v212 offset:15360
    s_waitcnt lgkmcnt(4)
    v_mfma_f32_16x16x32_bf16 v[32:35], v[112:115], a[40:43], v[32:35]
    v_cvt_pk_bf16_f32 v184, v158, v159
    v_cvt_pk_bf16_f32 v185, v160, v161
    v_mfma_f32_16x16x32_bf16 v[36:39], v[112:115], a[44:47], v[36:39]
    ds_read_b128 v[96:99], v212 offset:53248
    v_cvt_pk_bf16_f32 v186, v162, v163
    v_mfma_f32_16x16x32_bf16 v[40:43], v[116:119], a[40:43], v[40:43]
    buffer_load_dwordx4 v16, s[36:39], s73 offen offset:2048 sc1 lds
    v_bfi_b32 v187, s53, v30, v164
    v_mfma_f32_16x16x32_bf16 v[44:47], v[116:119], a[44:47], v[44:47]
    ds_read_b128 v[100:103], v212 offset:54272
    s_waitcnt vmcnt(13)
    v_mfma_f32_16x16x32_bf16 v[48:51], v[120:123], a[40:43], v[48:51]
    s_barrier
    v_add_f32 v255, 1.0, v255
    v_mfma_f32_16x16x32_bf16 v[52:55], v[120:123], a[44:47], v[52:55]
    ds_read_b128 v[104:107], v212 offset:55296
    v_mfma_f32_16x16x32_bf16 v[56:59], v[124:127], a[40:43], v[56:59]
    buffer_store_dwordx4 v[184:187], v16, s[36:39], s54 offen offset:2048 sc1
    v_mfma_f32_16x16x32_bf16 v[60:63], v[124:127], a[44:47], v[60:63]
    ds_read_b128 v[108:111], v212 offset:56320
    s_waitcnt lgkmcnt(4)
    v_mfma_f32_16x16x32_bf16 v[32:35], v[128:131], a[48:51], v[32:35]
    v_rcp_f32 v248, v248
    v_mfma_f32_16x16x32_bf16 v[36:39], v[128:131], a[52:55], v[36:39]
    ds_read_b128 v[112:115], v211 offset:16384
    v_mul_f32 v88, v88, v248
    v_mfma_f32_16x16x32_bf16 v[40:43], v[132:135], a[48:51], v[40:43]
    buffer_load_dwordx4 v16, s[36:39], s73 offen offset:3072 sc1 lds
    v_mfma_f32_16x16x32_bf16 v[44:47], v[132:135], a[52:55], v[44:47]
    ds_read_b128 v[116:119], v211 offset:17408
    v_mfma_f32_16x16x32_bf16 v[48:51], v[136:139], a[48:51], v[48:51]
    v_rcp_f32 v249, v249
    v_mfma_f32_16x16x32_bf16 v[52:55], v[136:139], a[52:55], v[52:55]
    ds_read_b128 v[120:123], v211 offset:18432
    v_mul_f32 v89, v89, v249
    v_mfma_f32_16x16x32_bf16 v[56:59], v[140:143], a[48:51], v[56:59]
    v_rcp_f32 v250, v250
    v_mfma_f32_16x16x32_bf16 v[60:63], v[140:143], a[52:55], v[60:63]
    ds_read_b128 v[124:127], v211 offset:19456
    s_waitcnt lgkmcnt(4)
    v_mfma_f32_16x16x32_bf16 v[32:35], v[96:99], a[56:59], v[32:35]
    s_add_u32 m0, s65, 8192
    v_cvt_pk_bf16_f32 v188, v165, v166
    v_mfma_f32_16x16x32_bf16 v[36:39], v[96:99], a[60:63], v[36:39]
    ds_read_b128 v[128:131], v211 offset:57344
    s_add_u32 s73, s96, s98
    v_mfma_f32_16x16x32_bf16 v[40:43], v[100:103], a[56:59], v[40:43]
    buffer_load_dwordx4 v16, s[36:39], s73 offen offset:0 sc1 lds
    v_cvt_pk_bf16_f32 v189, v167, v168
    v_mfma_f32_16x16x32_bf16 v[44:47], v[100:103], a[60:63], v[44:47]
    ds_read_b128 v[132:135], v211 offset:58368
    v_cvt_pk_bf16_f32 v190, v169, v170
    v_mfma_f32_16x16x32_bf16 v[48:51], v[104:107], a[56:59], v[48:51]
    v_bfi_b32 v191, s53, v30, v171
    v_mul_f32 v90, v90, v250
    v_mfma_f32_16x16x32_bf16 v[52:55], v[104:107], a[60:63], v[52:55]
    ds_read_b128 v[136:139], v211 offset:59392
    v_mfma_f32_16x16x32_bf16 v[56:59], v[108:111], a[56:59], v[56:59]
    buffer_store_dwordx4 v[188:191], v16, s[36:39], s54 offen offset:3072 sc1
    v_mfma_f32_16x16x32_bf16 v[60:63], v[108:111], a[60:63], v[60:63]
    ds_read_b128 v[140:143], v211 offset:60416
    s_waitcnt lgkmcnt(4)
    v_mfma_f32_16x16x32_bf16 v[32:35], v[112:115], a[64:67], v[32:35]
    v_rcp_f32 v251, v251
    v_mfma_f32_16x16x32_bf16 v[36:39], v[112:115], a[68:71], v[36:39]
    ds_read_b128 v[96:99], v212 offset:16384
    v_mul_f32 v91, v91, v251
    v_mfma_f32_16x16x32_bf16 v[40:43], v[116:119], a[64:67], v[40:43]
    buffer_load_dwordx4 v16, s[36:39], s73 offen offset:1024 sc1 lds
    v_mfma_f32_16x16x32_bf16 v[44:47], v[116:119], a[68:71], v[44:47]
    ds_read_b128 v[100:103], v212 offset:17408
    v_mfma_f32_16x16x32_bf16 v[48:51], v[120:123], a[64:67], v[48:51]
    v_rcp_f32 v252, v252
    v_mfma_f32_16x16x32_bf16 v[52:55], v[120:123], a[68:71], v[52:55]
    ds_read_b128 v[104:107], v212 offset:18432
    v_mul_f32 v92, v92, v252
    v_mfma_f32_16x16x32_bf16 v[56:59], v[124:127], a[64:67], v[56:59]
    v_rcp_f32 v253, v253
    v_mfma_f32_16x16x32_bf16 v[60:63], v[124:127], a[68:71], v[60:63]
    ds_read_b128 v[108:111], v212 offset:19456
    s_waitcnt lgkmcnt(4)
    v_mfma_f32_16x16x32_bf16 v[32:35], v[128:131], a[72:75], v[32:35]
    v_bfi_b32 v175, s53, v30, v175
    v_mul_f32 v93, v93, v253
    v_mfma_f32_16x16x32_bf16 v[36:39], v[128:131], a[76:79], v[36:39]
    ds_read_b128 v[112:115], v212 offset:57344
    v_mfma_f32_16x16x32_bf16 v[40:43], v[132:135], a[72:75], v[40:43]
    buffer_load_dwordx4 v16, s[36:39], s73 offen offset:2048 sc1 lds
    v_mfma_f32_16x16x32_bf16 v[44:47], v[132:135], a[76:79], v[44:47]
    ds_read_b128 v[116:119], v212 offset:58368
    s_waitcnt vmcnt(10)
    v_mfma_f32_16x16x32_bf16 v[48:51], v[136:139], a[72:75], v[48:51]
    s_barrier
    v_mfma_f32_16x16x32_bf16 v[52:55], v[136:139], a[76:79], v[52:55]
    ds_read_b128 v[120:123], v212 offset:59392
    v_mfma_f32_16x16x32_bf16 v[56:59], v[140:143], a[72:75], v[56:59]
    buffer_store_dwordx4 v[172:175], v16, s[36:39], s55 offen offset:0 sc1
    v_mfma_f32_16x16x32_bf16 v[60:63], v[140:143], a[76:79], v[60:63]
    ds_read_b128 v[124:127], v212 offset:60416
    s_waitcnt lgkmcnt(4)
    v_mfma_f32_16x16x32_bf16 v[32:35], v[96:99], a[80:83], v[32:35]
    v_rcp_f32 v254, v254
    v_mfma_f32_16x16x32_bf16 v[36:39], v[96:99], a[84:87], v[36:39]
    ds_read_b128 v[128:131], v211 offset:0
    v_mul_f32 v94, v94, v254
    v_mfma_f32_16x16x32_bf16 v[40:43], v[100:103], a[80:83], v[40:43]
    buffer_load_dwordx4 v16, s[36:39], s73 offen offset:3072 sc1 lds
    v_mfma_f32_16x16x32_bf16 v[44:47], v[100:103], a[84:87], v[44:47]
    ds_read_b128 v[132:135], v211 offset:1024
    v_mfma_f32_16x16x32_bf16 v[48:51], v[104:107], a[80:83], v[48:51]
    v_rcp_f32 v255, v255
    v_mfma_f32_16x16x32_bf16 v[52:55], v[104:107], a[84:87], v[52:55]
    ds_read_b128 v[136:139], v211 offset:2048
    v_mul_f32 v95, v95, v255
    v_mfma_f32_16x16x32_bf16 v[56:59], v[108:111], a[80:83], v[56:59]
    v_mfma_f32_16x16x32_bf16 v[60:63], v[108:111], a[84:87], v[60:63]
    ds_read_b128 v[140:143], v211 offset:3072
    s_waitcnt lgkmcnt(4)
    v_mfma_f32_16x16x32_bf16 v[32:35], v[112:115], a[88:91], v[32:35]
    s_add_u32 m0, s65, 12288
    v_mfma_f32_16x16x32_bf16 v[36:39], v[112:115], a[92:95], v[36:39]
    ds_read_b128 v[96:99], v211 offset:40960
    s_add_u32 s73, s96, s99
    v_mfma_f32_16x16x32_bf16 v[40:43], v[116:119], a[88:91], v[40:43]
    buffer_load_dwordx4 v16, s[36:39], s73 offen offset:0 sc1 lds
    v_mfma_f32_16x16x32_bf16 v[44:47], v[116:119], a[92:95], v[44:47]
    ds_read_b128 v[100:103], v211 offset:41984
    v_mfma_f32_16x16x32_bf16 v[48:51], v[120:123], a[88:91], v[48:51]
    v_mfma_f32_16x16x32_bf16 v[52:55], v[120:123], a[92:95], v[52:55]
    ds_read_b128 v[104:107], v211 offset:43008
    v_mfma_f32_16x16x32_bf16 v[56:59], v[124:127], a[88:91], v[56:59]
    v_mfma_f32_16x16x32_bf16 v[60:63], v[124:127], a[92:95], v[60:63]
    ds_read_b128 v[108:111], v211 offset:44032
    s_waitcnt lgkmcnt(4)
    v_mfma_f32_16x16x32_bf16 v[32:35], v[128:131], a[96:99], v[32:35]
    v_mfma_f32_16x16x32_bf16 v[36:39], v[128:131], a[100:103], v[36:39]
    ds_read_b128 v[112:115], v212 offset:0
    v_mfma_f32_16x16x32_bf16 v[40:43], v[132:135], a[96:99], v[40:43]
    buffer_load_dwordx4 v16, s[36:39], s73 offen offset:1024 sc1 lds
    v_mfma_f32_16x16x32_bf16 v[44:47], v[132:135], a[100:103], v[44:47]
    ds_read_b128 v[116:119], v212 offset:1024
    v_mfma_f32_16x16x32_bf16 v[48:51], v[136:139], a[96:99], v[48:51]
    v_mfma_f32_16x16x32_bf16 v[52:55], v[136:139], a[100:103], v[52:55]
    ds_read_b128 v[120:123], v212 offset:2048
    v_mfma_f32_16x16x32_bf16 v[56:59], v[140:143], a[96:99], v[56:59]
    v_mfma_f32_16x16x32_bf16 v[60:63], v[140:143], a[100:103], v[60:63]
    ds_read_b128 v[124:127], v212 offset:3072
    s_waitcnt lgkmcnt(4)
    v_mfma_f32_16x16x32_bf16 v[32:35], v[96:99], a[104:107], v[32:35]
    v_mfma_f32_16x16x32_bf16 v[36:39], v[96:99], a[108:111], v[36:39]
    ds_read_b128 v[128:131], v212 offset:40960
    v_mfma_f32_16x16x32_bf16 v[40:43], v[100:103], a[104:107], v[40:43]
    buffer_load_dwordx4 v16, s[36:39], s73 offen offset:2048 sc1 lds
    v_mfma_f32_16x16x32_bf16 v[44:47], v[100:103], a[108:111], v[44:47]
    ds_read_b128 v[132:135], v212 offset:41984
    s_waitcnt vmcnt(9)
    v_mfma_f32_16x16x32_bf16 v[48:51], v[104:107], a[104:107], v[48:51]
    s_barrier
    v_mfma_f32_16x16x32_bf16 v[52:55], v[104:107], a[108:111], v[52:55]
    ds_read_b128 v[136:139], v212 offset:43008
    v_mfma_f32_16x16x32_bf16 v[56:59], v[108:111], a[104:107], v[56:59]
    v_mfma_f32_16x16x32_bf16 v[60:63], v[108:111], a[108:111], v[60:63]
    ds_read_b128 v[140:143], v212 offset:44032
    s_waitcnt lgkmcnt(4)
    v_mfma_f32_16x16x32_bf16 v[32:35], v[112:115], a[112:115], v[32:35]
    v_mfma_f32_16x16x32_bf16 v[36:39], v[112:115], a[116:119], v[36:39]
    ds_read_b128 v[96:99], v211 offset:4096
    v_mfma_f32_16x16x32_bf16 v[40:43], v[116:119], a[112:115], v[40:43]
    buffer_load_dwordx4 v16, s[36:39], s73 offen offset:3072 sc1 lds
    v_mfma_f32_16x16x32_bf16 v[44:47], v[116:119], a[116:119], v[44:47]
    ds_read_b128 v[100:103], v211 offset:5120
    v_mfma_f32_16x16x32_bf16 v[48:51], v[120:123], a[112:115], v[48:51]
    v_mfma_f32_16x16x32_bf16 v[52:55], v[120:123], a[116:119], v[52:55]
    ds_read_b128 v[104:107], v211 offset:6144
    v_mfma_f32_16x16x32_bf16 v[56:59], v[124:127], a[112:115], v[56:59]
    v_mfma_f32_16x16x32_bf16 v[60:63], v[124:127], a[116:119], v[60:63]
    ds_read_b128 v[108:111], v211 offset:7168
    s_waitcnt lgkmcnt(4)
    v_mfma_f32_16x16x32_bf16 v[32:35], v[128:131], a[120:123], v[32:35]
    s_add_u32 m0, s65, 16384
    v_mfma_f32_16x16x32_bf16 v[36:39], v[128:131], a[124:127], v[36:39]
    ds_read_b128 v[112:115], v211 offset:45056
    s_add_u32 s73, s96, s100
    v_mfma_f32_16x16x32_bf16 v[40:43], v[132:135], a[120:123], v[40:43]
    buffer_load_dwordx4 v16, s[36:39], s73 offen offset:0 sc1 lds
    v_mfma_f32_16x16x32_bf16 v[44:47], v[132:135], a[124:127], v[44:47]
    ds_read_b128 v[116:119], v211 offset:46080
    v_mfma_f32_16x16x32_bf16 v[48:51], v[136:139], a[120:123], v[48:51]
    v_mfma_f32_16x16x32_bf16 v[52:55], v[136:139], a[124:127], v[52:55]
    ds_read_b128 v[120:123], v211 offset:47104
    v_mfma_f32_16x16x32_bf16 v[56:59], v[140:143], a[120:123], v[56:59]
    v_mfma_f32_16x16x32_bf16 v[60:63], v[140:143], a[124:127], v[60:63]
    ds_read_b128 v[124:127], v211 offset:48128
    s_waitcnt lgkmcnt(4)
    v_mfma_f32_16x16x32_bf16 v[32:35], v[96:99], a[128:131], v[32:35]
    v_mfma_f32_16x16x32_bf16 v[36:39], v[96:99], a[132:135], v[36:39]
    ds_read_b128 v[128:131], v212 offset:4096
    v_mfma_f32_16x16x32_bf16 v[40:43], v[100:103], a[128:131], v[40:43]
    buffer_load_dwordx4 v16, s[36:39], s73 offen offset:1024 sc1 lds
    v_mfma_f32_16x16x32_bf16 v[44:47], v[100:103], a[132:135], v[44:47]
    ds_read_b128 v[132:135], v212 offset:5120
    v_mfma_f32_16x16x32_bf16 v[48:51], v[104:107], a[128:131], v[48:51]
    v_mfma_f32_16x16x32_bf16 v[52:55], v[104:107], a[132:135], v[52:55]
    ds_read_b128 v[136:139], v212 offset:6144
    v_mfma_f32_16x16x32_bf16 v[56:59], v[108:111], a[128:131], v[56:59]
    buffer_load_dwordx4 v16, s[36:39], s73 offen offset:2048 sc1 lds
    v_mfma_f32_16x16x32_bf16 v[60:63], v[108:111], a[132:135], v[60:63]
    ds_read_b128 v[140:143], v212 offset:7168
    s_waitcnt lgkmcnt(4)
    v_mfma_f32_16x16x32_bf16 v[32:35], v[112:115], a[136:139], v[32:35]
    v_mfma_f32_16x16x32_bf16 v[36:39], v[112:115], a[140:143], v[36:39]
    ds_read_b128 v[96:99], v212 offset:45056
    v_mfma_f32_16x16x32_bf16 v[40:43], v[116:119], a[136:139], v[40:43]
    buffer_load_dwordx4 v16, s[36:39], s73 offen offset:3072 sc1 lds
    v_mfma_f32_16x16x32_bf16 v[44:47], v[116:119], a[140:143], v[44:47]
    ds_read_b128 v[100:103], v212 offset:46080
    s_waitcnt vmcnt(8)
    v_mfma_f32_16x16x32_bf16 v[48:51], v[120:123], a[136:139], v[48:51]
    s_barrier
    v_mfma_f32_16x16x32_bf16 v[52:55], v[120:123], a[140:143], v[52:55]
    ds_read_b128 v[104:107], v212 offset:47104
    v_mfma_f32_16x16x32_bf16 v[56:59], v[124:127], a[136:139], v[56:59]
    buffer_load_dwordx4 v[176:179], v16, s[36:39], s12 offen offset:0 sc1
    v_mfma_f32_16x16x32_bf16 v[60:63], v[124:127], a[140:143], v[60:63]
    ds_read_b128 v[108:111], v212 offset:48128
    s_waitcnt lgkmcnt(4)
    v_mfma_f32_16x16x32_bf16 v[32:35], v[128:131], a[144:147], v[32:35]
    s_add_u32 m0, s65, 28672
    v_mfma_f32_16x16x32_bf16 v[36:39], v[128:131], a[148:151], v[36:39]
    ds_read_b128 v[112:115], v211 offset:8192
    s_mul_i32 s73, s76, 896
    v_mfma_f32_16x16x32_bf16 v[40:43], v[132:135], a[144:147], v[40:43]
    buffer_load_dwordx4 v214, s[32:35], s73 offen offset:0 lds
    v_mfma_f32_16x16x32_bf16 v[44:47], v[132:135], a[148:151], v[44:47]
    ds_read_b128 v[116:119], v211 offset:9216
    v_mfma_f32_16x16x32_bf16 v[48:51], v[136:139], a[144:147], v[48:51]
    v_mfma_f32_16x16x32_bf16 v[52:55], v[136:139], a[148:151], v[52:55]
    ds_read_b128 v[120:123], v211 offset:10240
    v_mfma_f32_16x16x32_bf16 v[56:59], v[140:143], a[144:147], v[56:59]
    buffer_load_dwordx4 v[180:183], v16, s[36:39], s12 offen offset:1024 sc1
    v_mfma_f32_16x16x32_bf16 v[60:63], v[140:143], a[148:151], v[60:63]
    ds_read_b128 v[124:127], v211 offset:11264
    s_waitcnt lgkmcnt(4)
    v_mfma_f32_16x16x32_bf16 v[32:35], v[96:99], a[152:155], v[32:35]
    v_mfma_f32_16x16x32_bf16 v[36:39], v[96:99], a[156:159], v[36:39]
    ds_read_b128 v[128:131], v211 offset:49152
    v_mfma_f32_16x16x32_bf16 v[40:43], v[100:103], a[152:155], v[40:43]
    buffer_load_dwordx4 v215, s[32:35], s73 offen offset:1024 lds
    v_mfma_f32_16x16x32_bf16 v[44:47], v[100:103], a[156:159], v[44:47]
    ds_read_b128 v[132:135], v211 offset:50176
    v_mfma_f32_16x16x32_bf16 v[48:51], v[104:107], a[152:155], v[48:51]
    v_mfma_f32_16x16x32_bf16 v[52:55], v[104:107], a[156:159], v[52:55]
    ds_read_b128 v[136:139], v211 offset:51200
    v_mfma_f32_16x16x32_bf16 v[56:59], v[108:111], a[152:155], v[56:59]
    buffer_load_dwordx4 v[184:187], v16, s[36:39], s12 offen offset:2048 sc1
    v_mfma_f32_16x16x32_bf16 v[60:63], v[108:111], a[156:159], v[60:63]
    ds_read_b128 v[140:143], v211 offset:52224
    s_waitcnt lgkmcnt(4)
    v_mfma_f32_16x16x32_bf16 v[32:35], v[112:115], a[160:163], v[32:35]
    v_mfma_f32_16x16x32_bf16 v[36:39], v[112:115], a[164:167], v[36:39]
    ds_read_b128 v[96:99], v212 offset:8192
    v_mfma_f32_16x16x32_bf16 v[40:43], v[116:119], a[160:163], v[40:43]
    buffer_load_dwordx4 v[188:191], v16, s[36:39], s12 offen offset:3072 sc1
    v_mfma_f32_16x16x32_bf16 v[44:47], v[116:119], a[164:167], v[44:47]
    ds_read_b128 v[100:103], v212 offset:9216
    v_mfma_f32_16x16x32_bf16 v[48:51], v[120:123], a[160:163], v[48:51]
    v_mfma_f32_16x16x32_bf16 v[52:55], v[120:123], a[164:167], v[52:55]
    ds_read_b128 v[104:107], v212 offset:10240
    v_mfma_f32_16x16x32_bf16 v[56:59], v[124:127], a[160:163], v[56:59]
    v_mfma_f32_16x16x32_bf16 v[60:63], v[124:127], a[164:167], v[60:63]
    ds_read_b128 v[108:111], v212 offset:11264
    s_waitcnt lgkmcnt(4)
    v_mfma_f32_16x16x32_bf16 v[32:35], v[128:131], a[168:171], v[32:35]
    v_mfma_f32_16x16x32_bf16 v[36:39], v[128:131], a[172:175], v[36:39]
    ds_read_b128 v[112:115], v212 offset:49152
    v_mfma_f32_16x16x32_bf16 v[40:43], v[132:135], a[168:171], v[40:43]
    buffer_load_dwordx4 v216, s[32:35], s73 offen offset:2048 lds
    v_mfma_f32_16x16x32_bf16 v[44:47], v[132:135], a[172:175], v[44:47]
    ds_read_b128 v[116:119], v212 offset:50176
    s_waitcnt vmcnt(11)
    v_mfma_f32_16x16x32_bf16 v[48:51], v[136:139], a[168:171], v[48:51]
    s_barrier
    v_mfma_f32_16x16x32_bf16 v[52:55], v[136:139], a[172:175], v[52:55]
L_pad5:
    s_cbranch_execz L_hop2
    ds_read_b128 v[120:123], v212 offset:51200
    v_mfma_f32_16x16x32_bf16 v[56:59], v[140:143], a[168:171], v[56:59]
    buffer_load_dwordx4 v[192:195], v16, s[36:39], s13 offen offset:0 sc1
    v_mfma_f32_16x16x32_bf16 v[60:63], v[140:143], a[172:175], v[60:63]
    ds_read_b128 v[124:127], v212 offset:52224
    s_waitcnt lgkmcnt(4)
    v_mfma_f32_16x16x32_bf16 v[32:35], v[96:99], a[176:179], v[32:35]
    v_mfma_f32_16x16x32_bf16 v[36:39], v[96:99], a[180:183], v[36:39]
    ds_read_b128 v[128:131], v211 offset:12288
    v_mfma_f32_16x16x32_bf16 v[40:43], v[100:103], a[176:179], v[40:43]
    buffer_load_dwordx4 v217, s[32:35], s73 offen offset:3072 lds
    v_mfma_f32_16x16x32_bf16 v[44:47], v[100:103], a[180:183], v[44:47]
    ds_read_b128 v[132:135], v211 offset:13312
    v_mfma_f32_16x16x32_bf16 v[48:51], v[104:107], a[176:179], v[48:51]
    s_add_u32 m0, s65, 32768
    v_mfma_f32_16x16x32_bf16 v[52:55], v[104:107], a[180:183], v[52:55]
    ds_read_b128 v[136:139], v211 offset:14336
    s_mul_i32 s73, s77, 896
    v_mfma_f32_16x16x32_bf16 v[56:59], v[108:111], a[176:179], v[56:59]
    buffer_load_dwordx4 v214, s[32:35], s73 offen offset:0 lds
    v_mfma_f32_16x16x32_bf16 v[60:63], v[108:111], a[180:183], v[60:63]
    ds_read_b128 v[140:143], v211 offset:15360
    s_waitcnt lgkmcnt(4)
    v_mfma_f32_16x16x32_bf16 v[32:35], v[112:115], a[184:187], v[32:35]
    v_mfma_f32_16x16x32_bf16 v[36:39], v[112:115], a[188:191], v[36:39]
    ds_read_b128 v[96:99], v211 offset:53248
    v_mfma_f32_16x16x32_bf16 v[40:43], v[116:119], a[184:187], v[40:43]
    buffer_load_dwordx4 v215, s[32:35], s73 offen offset:1024 lds
    v_mfma_f32_16x16x32_bf16 v[44:47], v[116:119], a[188:191], v[44:47]
    ds_read_b128 v[100:103], v211 offset:54272
    v_mfma_f32_16x16x32_bf16 v[48:51], v[120:123], a[184:187], v[48:51]
    v_mfma_f32_16x16x32_bf16 v[52:55], v[120:123], a[188:191], v[52:55]
    ds_read_b128 v[104:107], v211 offset:55296
    v_mfma_f32_16x16x32_bf16 v[56:59], v[124:127], a[184:187], v[56:59]
    buffer_load_dwordx4 v216, s[32:35], s73 offen offset:2048 lds
    v_mfma_f32_16x16x32_bf16 v[60:63], v[124:127], a[188:191], v[60:63]
    ds_read_b128 v[108:111], v211 offset:56320
    s_waitcnt lgkmcnt(4)
    v_mfma_f32_16x16x32_bf16 v[32:35], v[128:131], a[192:195], v[32:35]
    v_mfma_f32_16x16x32_bf16 v[36:39], v[128:131], a[196:199], v[36:39]
    ds_read_b128 v[112:115], v212 offset:12288
    v_mfma_f32_16x16x32_bf16 v[40:43], v[132:135], a[192:195], v[40:43]
    buffer_load_dwordx4 v217, s[32:35], s73 offen offset:3072 lds
    v_mfma_f32_16x16x32_bf16 v[44:47], v[132:135], a[196:199], v[44:47]
    ds_read_b128 v[116:119], v212 offset:13312
    v_mfma_f32_16x16x32_bf16 v[48:51], v[136:139], a[192:195], v[48:51]
    v_mfma_f32_16x16x32_bf16 v[52:55], v[136:139], a[196:199], v[52:55]
    ds_read_b128 v[120:123], v212 offset:14336
    v_mfma_f32_16x16x32_bf16 v[56:59], v[140:143], a[192:195], v[56:59]
    v_mfma_f32_16x16x32_bf16 v[60:63], v[140:143], a[196:199], v[60:63]
    ds_read_b128 v[124:127], v212 offset:15360
    s_waitcnt lgkmcnt(4)
    v_mfma_f32_16x16x32_bf16 v[32:35], v[96:99], a[200:203], v[32:35]
    s_waitcnt vmcnt(12)
    v_xor_b32 v179, v30, v179
    v_mfma_f32_16x16x32_bf16 v[36:39], v[96:99], a[204:207], v[36:39]
    ds_read_b128 v[128:131], v212 offset:53248
    v_or_b32 v248, v179, v179
    v_mfma_f32_16x16x32_bf16 v[40:43], v[100:103], a[200:203], v[40:43]
    v_lshlrev_b32 v144, 16, v176
    v_and_b32 v145, s14, v176
    v_mfma_f32_16x16x32_bf16 v[44:47], v[100:103], a[204:207], v[44:47]
    ds_read_b128 v[132:135], v212 offset:54272
    v_mfma_f32_16x16x32_bf16 v[48:51], v[104:107], a[200:203], v[48:51]
    s_barrier
    v_lshlrev_b32 v146, 16, v177
    v_mfma_f32_16x16x32_bf16 v[52:55], v[104:107], a[204:207], v[52:55]
    ds_read_b128 v[136:139], v212 offset:55296
    v_and_b32 v147, s14, v177
    v_mfma_f32_16x16x32_bf16 v[56:59], v[108:111], a[200:203], v[56:59]
    v_lshlrev_b32 v148, 16, v178
    v_and_b32 v149, s14, v178
    v_mfma_f32_16x16x32_bf16 v[60:63], v[108:111], a[204:207], v[60:63]
    ds_read_b128 v[140:143], v212 offset:56320
    s_waitcnt lgkmcnt(4)
    v_mfma_f32_16x16x32_bf16 v[32:35], v[112:115], a[208:211], v[32:35]
    v_mul_f32 v144, v144, v64
    v_mul_f32 v145, v145, v65
    v_mfma_f32_16x16x32_bf16 v[36:39], v[112:115], a[212:215], v[36:39]
    ds_read_b128 v[96:99], v211 offset:16384
    v_mul_f32 v146, v146, v66
    v_mfma_f32_16x16x32_bf16 v[40:43], v[116:119], a[208:211], v[40:43]
    v_mul_f32 v147, v147, v67
    v_mul_f32 v148, v148, v68
    v_mfma_f32_16x16x32_bf16 v[44:47], v[116:119], a[212:215], v[44:47]
    ds_read_b128 v[100:103], v211 offset:17408
    v_mul_f32 v149, v149, v69
    v_mfma_f32_16x16x32_bf16 v[48:51], v[120:123], a[208:211], v[48:51]
    v_mul_f32 v150, v179, v70
    s_waitcnt vmcnt(10)
    v_mfma_f32_16x16x32_bf16 v[52:55], v[120:123], a[212:215], v[52:55]
    ds_read_b128 v[104:107], v211 offset:18432
    v_xor_b32 v183, v30, v183
    v_mfma_f32_16x16x32_bf16 v[56:59], v[124:127], a[208:211], v[56:59]
    v_or_b32 v248, v248, v183
    v_lshlrev_b32 v151, 16, v180
    v_mfma_f32_16x16x32_bf16 v[60:63], v[124:127], a[212:215], v[60:63]
    ds_read_b128 v[108:111], v211 offset:19456
    s_waitcnt lgkmcnt(4)
    v_mfma_f32_16x16x32_bf16 v[32:35], v[128:131], a[216:219], v[32:35]
    v_and_b32 v152, s14, v180
    v_lshlrev_b32 v153, 16, v181
    v_mfma_f32_16x16x32_bf16 v[36:39], v[128:131], a[220:223], v[36:39]
    ds_read_b128 v[112:115], v211 offset:57344
    v_and_b32 v154, s14, v181
    v_mfma_f32_16x16x32_bf16 v[40:43], v[132:135], a[216:219], v[40:43]
    v_lshlrev_b32 v155, 16, v182
    v_and_b32 v156, s14, v182
    v_mfma_f32_16x16x32_bf16 v[44:47], v[132:135], a[220:223], v[44:47]
    ds_read_b128 v[116:119], v211 offset:58368
    v_mul_f32 v151, v151, v71
    v_mfma_f32_16x16x32_bf16 v[48:51], v[136:139], a[216:219], v[48:51]
    v_mul_f32 v152, v152, v72
    v_mul_f32 v153, v153, v73
    v_mfma_f32_16x16x32_bf16 v[52:55], v[136:139], a[220:223], v[52:55]
    ds_read_b128 v[120:123], v211 offset:59392
    v_mul_f32 v154, v154, v74
    v_mfma_f32_16x16x32_bf16 v[56:59], v[140:143], a[216:219], v[56:59]
    v_mul_f32 v155, v155, v75
    v_mul_f32 v156, v156, v76
    v_mfma_f32_16x16x32_bf16 v[60:63], v[140:143], a[220:223], v[60:63]
    ds_read_b128 v[124:127], v211 offset:60416
    s_waitcnt lgkmcnt(4)
    v_mfma_f32_16x16x32_bf16 v[32:35], v[96:99], a[224:227], v[32:35]
    v_mul_f32 v157, v183, v77
    s_waitcnt vmcnt(8)
    v_mfma_f32_16x16x32_bf16 v[36:39], v[96:99], a[228:231], v[36:39]
    ds_read_b128 v[128:131], v212 offset:16384
    v_xor_b32 v187, v30, v187
    v_mfma_f32_16x16x32_bf16 v[40:43], v[100:103], a[224:227], v[40:43]
    v_or_b32 v248, v248, v187
    v_lshlrev_b32 v158, 16, v184
    v_mfma_f32_16x16x32_bf16 v[44:47], v[100:103], a[228:231], v[44:47]
    ds_read_b128 v[132:135], v212 offset:17408
    v_and_b32 v159, s14, v184
    v_mfma_f32_16x16x32_bf16 v[48:51], v[104:107], a[224:227], v[48:51]
    v_lshlrev_b32 v160, 16, v185
    v_and_b32 v161, s14, v185
    v_mfma_f32_16x16x32_bf16 v[52:55], v[104:107], a[228:231], v[52:55]
    ds_read_b128 v[136:139], v212 offset:18432
    v_lshlrev_b32 v162, 16, v186
    v_mfma_f32_16x16x32_bf16 v[56:59], v[108:111], a[224:227], v[56:59]
    v_and_b32 v163, s14, v186
    v_mul_f32 v158, v158, v78
    v_mfma_f32_16x16x32_bf16 v[60:63], v[108:111], a[228:231], v[60:63]
    ds_read_b128 v[140:143], v212 offset:19456
    s_waitcnt lgkmcnt(4)
    v_mfma_f32_16x16x32_bf16 v[32:35], v[112:115], a[232:235], v[32:35]
    v_mul_f32 v159, v159, v79
    v_mul_f32 v160, v160, v80
    v_mfma_f32_16x16x32_bf16 v[36:39], v[112:115], a[236:239], v[36:39]
    ds_read_b128 v[96:99], v212 offset:57344
    v_mul_f32 v161, v161, v81
    v_mfma_f32_16x16x32_bf16 v[40:43], v[116:119], a[232:235], v[40:43]
    v_mul_f32 v162, v162, v82
    v_mul_f32 v163, v163, v83
    v_mfma_f32_16x16x32_bf16 v[44:47], v[116:119], a[236:239], v[44:47]
    ds_read_b128 v[100:103], v212 offset:58368
    v_mul_f32 v164, v187, v84
    v_mfma_f32_16x16x32_bf16 v[48:51], v[120:123], a[232:235], v[48:51]
    s_waitcnt vmcnt(7)
    v_xor_b32 v191, v30, v191
    v_mfma_f32_16x16x32_bf16 v[52:55], v[120:123], a[236:239], v[52:55]
    ds_read_b128 v[104:107], v212 offset:59392
    v_or_b32 v248, v248, v191
    v_mfma_f32_16x16x32_bf16 v[56:59], v[124:127], a[232:235], v[56:59]
    v_lshlrev_b32 v165, 16, v188
    v_and_b32 v166, s14, v188
    v_mfma_f32_16x16x32_bf16 v[60:63], v[124:127], a[236:239], v[60:63]
    ds_read_b128 v[108:111], v212 offset:60416
    s_waitcnt lgkmcnt(4)
    v_mfma_f32_16x16x32_bf16 v[32:35], v[128:131], a[240:243], v[32:35]
    v_lshlrev_b32 v167, 16, v189
    v_and_b32 v168, s14, v189
    v_mfma_f32_16x16x32_bf16 v[36:39], v[128:131], a[244:247], v[36:39]
    v_lshlrev_b32 v169, 16, v190
    v_and_b32 v170, s14, v190
    v_mfma_f32_16x16x32_bf16 v[40:43], v[132:135], a[240:243], v[40:43]
    v_mul_f32 v165, v165, v85
    v_mul_f32 v166, v166, v86
    v_mfma_f32_16x16x32_bf16 v[44:47], v[132:135], a[244:247], v[44:47]
    v_mul_f32 v167, v167, v87
    v_mul_f32 v168, v168, v88
    v_mfma_f32_16x16x32_bf16 v[48:51], v[136:139], a[240:243], v[48:51]
    v_mul_f32 v169, v169, v89
    v_mul_f32 v170, v170, v90
    v_mfma_f32_16x16x32_bf16 v[52:55], v[136:139], a[244:247], v[52:55]
    v_mul_f32 v171, v191, v91
    s_waitcnt vmcnt(5)
    v_mfma_f32_16x16x32_bf16 v[56:59], v[140:143], a[240:243], v[56:59]
    v_xor_b32 v195, v30, v195
    v_or_b32 v248, v248, v195
    v_mfma_f32_16x16x32_bf16 v[60:63], v[140:143], a[244:247], v[60:63]
    s_waitcnt lgkmcnt(0)
    v_mfma_f32_16x16x32_bf16 v[32:35], v[96:99], a[248:251], v[32:35]
    v_mul_f32 v172, v192, v92
    v_mul_f32 v173, v193, v93
    v_mfma_f32_16x16x32_bf16 v[36:39], v[96:99], a[252:255], v[36:39]
    v_mul_f32 v174, v194, v94
    v_mul_f32 v175, v195, v95
    v_mfma_f32_16x16x32_bf16 v[40:43], v[100:103], a[248:251], v[40:43]
    v_and_b32 v248, 0xff, v248
    v_cmp_ne_u32 vcc, 0, v248
    v_mfma_f32_16x16x32_bf16 v[44:47], v[100:103], a[252:255], v[44:47]
    v_mfma_f32_16x16x32_bf16 v[48:51], v[104:107], a[248:251], v[48:51]
    v_mfma_f32_16x16x32_bf16 v[52:55], v[104:107], a[252:255], v[52:55]
    v_mfma_f32_16x16x32_bf16 v[56:59], v[108:111], a[248:251], v[56:59]
    v_mfma_f32_16x16x32_bf16 v[60:63], v[108:111], a[252:255], v[60:63]
    s_cmp_lg_u64 vcc, 0
    s_cbranch_scc1 L_slow_7
L_back_8:
    v_pk_fma_f32 v[32:33], v[32:33], v[64:65], v[144:145]
    v_pk_fma_f32 v[34:35], v[34:35], v[66:67], v[146:147]
    v_cvt_pk_bf16_f32 v96, v32, v33
    v_cvt_pk_bf16_f32 v97, v34, v35
    v_pk_fma_f32 v[40:41], v[40:41], v[72:73], v[152:153]
    v_pk_fma_f32 v[42:43], v[42:43], v[74:75], v[154:155]
    v_cvt_pk_bf16_f32 v98, v40, v41
    v_cvt_pk_bf16_f32 v99, v42, v43
    buffer_store_dwordx4 v[96:99], v16, s[36:39], s18 offen offset:0 sc1
    v_pk_fma_f32 v[48:49], v[48:49], v[80:81], v[160:161]
    v_pk_fma_f32 v[50:51], v[50:51], v[82:83], v[162:163]
    v_cvt_pk_bf16_f32 v100, v48, v49
    v_cvt_pk_bf16_f32 v101, v50, v51
    v_pk_fma_f32 v[56:57], v[56:57], v[88:89], v[168:169]
    v_pk_fma_f32 v[58:59], v[58:59], v[90:91], v[170:171]
    v_cvt_pk_bf16_f32 v102, v56, v57
    v_cvt_pk_bf16_f32 v103, v58, v59
    buffer_store_dwordx4 v[100:103], v16, s[36:39], s18 offen offset:1024 sc1
    v_pk_fma_f32 v[36:37], v[36:37], v[68:69], v[148:149]
    v_pk_fma_f32 v[38:39], v[38:39], v[70:71], v[150:151]
    v_cvt_pk_bf16_f32 v104, v36, v37
    v_cvt_pk_bf16_f32 v105, v38, v39
    v_pk_fma_f32 v[44:45], v[44:45], v[76:77], v[156:157]
    v_pk_fma_f32 v[46:47], v[46:47], v[78:79], v[158:159]
    v_cvt_pk_bf16_f32 v106, v44, v45
    v_cvt_pk_bf16_f32 v107, v46, v47
    buffer_store_dwordx4 v[104:107], v16, s[36:39], s19 offen offset:0 sc1
    v_pk_fma_f32 v[52:53], v[52:53], v[84:85], v[164:165]
    v_pk_fma_f32 v[54:55], v[54:55], v[86:87], v[166:167]
    v_cvt_pk_bf16_f32 v108, v52, v53
    v_cvt_pk_bf16_f32 v109, v54, v55
    v_pk_fma_f32 v[60:61], v[60:61], v[92:93], v[172:173]
    v_pk_fma_f32 v[62:63], v[62:63], v[94:95], v[174:175]
    v_cvt_pk_bf16_f32 v110, v60, v61
    v_cvt_pk_bf16_f32 v111, v62, v63
    buffer_store_dwordx4 v[108:111], v16, s[36:39], s19 offen offset:1024 sc1
    s_mul_i32 s70, s63, 293
    s_lshr_b32 s70, s70, 6
    v_min_u32 v245, 5, v1
    v_add_u32 v245, s70, v245
    v_min_u32 v245, 31, v245
    v_mul_u32_u24 v245, 128, v245
    v_add_u32 v245, 32768, v245
    s_lshl_b32 s67, s60, 1
    s_add_u32 s67, s67, s62
    s_and_b32 s69, s64, 1
    s_lshl_b32 s70, s67, 1
    s_add_u32 s70, s70, s69
    s_mul_i32 s70, s70, 28672
    s_lshl_b32 s72, s63, 7
    s_add_u32 s70, s70, s72
    s_lshr_b32 s72, s64, 1
    s_lshl_b32 s72, s72, 6
    s_add_u32 s72, s70, s72
    s_add_u32 s83, s72, 14336
    v_and_b32 v252, 15, v1
    v_mul_u32_u24 v26, 896, v252
    v_lshrrev_b32 v251, 5, v1
    s_and_b32 s70, s64, 2
    s_lshl_b32 s70, s70, 1
    v_add_u32 v251, s70, v251
    v_xor_b32 v251, v251, v1
    v_and_b32 v251, 7, v251
    v_lshlrev_b32 v251, 4, v251
    v_lshl_add_u32 v251, v252, 7, v251
    v_bfe_u32 v253, v1, 4, 1
    v_lshl_add_u32 v251, v253, 3, v251
    s_mul_i32 s70, s69, 81920
    s_add_u32 s70, s70, 38912
    v_add_u32 v24, s70, v251
    v_xor_b32 v25, 32, v24
    v_lshrrev_b32 v251, 5, v1
    v_bfe_u32 v252, v1, 2, 3
    v_lshlrev_b32 v253, 7, v252
    v_and_b32 v254, 3, v1
    v_lshl_add_u32 v253, v254, 3, v253
    v_bfe_u32 v254, v1, 3, 2
    v_lshl_add_u32 v253, v254, 5, v253
    s_and_b32 s70, s64, 2
    s_lshl_b32 s70, s70, 5
    v_xor_b32 v254, s70, v253
    v_mul_u32_u24 v252, 40960, v251
    s_lshl_b32 s70, s70, 5
    v_add3_u32 v72, v252, v254, s70
    v_xor_b32 v73, 32, v72
    v_xor_b32 v74, 64, v72
    v_xor_b32 v75, 96, v72
    v_add_u32 v76, 81920, v72
    v_add_u32 v77, 81920, v73
    v_add_u32 v78, 81920, v74
    v_add_u32 v79, 81920, v75
    s_lshl_b32 s70, s69, 6
    v_xor_b32 v254, s70, v253
    v_lshl_add_u32 v254, v251, 10, v254
    s_and_b32 s70, s64, 2
    s_mul_i32 s70, s70, 40960
    s_add_u32 s70, s70, 16384
    v_add_u32 v14, s70, v254
    v_xor_b32 v15, 32, v14
    ds_read_b64_tr_b16 v[64:65], v14 offset:20480
    ds_read_b64_tr_b16 v[66:67], v15 offset:20480
    ds_read_b64_tr_b16 v[68:69], v14 offset:61440
    ds_read_b64_tr_b16 v[70:71], v15 offset:61440
    v_bfe_u32 v252, v1, 3, 1
    v_lshrrev_b32 v253, 4, v1
    v_lshl_add_u32 v252, v252, 5, v253
    v_lshl_add_u32 v20, v252, 12, v218
    v_add_u32 v21, 15360, v20
    s_lshl_b32 s81, s63, 3
    s_add_u32 s81, s81, s64
    s_lshl_b32 s81, s81, 15
    s_lshl_b32 s71, s67, 7
    s_add_u32 s81, s81, s71
    s_add_u32 s81, s81, 3145728
    s_lshl_b32 s92, s67, 1
    s_add_u32 s92, s92, s69
    s_mul_i32 s92, s92, 57344
    s_and_b32 s71, s64, 2
    s_lshl_b32 s71, s71, 10
    s_add_u32 s92, s92, s71
    s_add_u32 s92, s92, 9437184
    s_lshl_b32 s85, s74, 5
    s_add_u32 s85, s85, s92
    s_lshl_b32 s86, s75, 5
    s_add_u32 s86, s86, s92
    s_lshl_b32 s87, s76, 5
    s_add_u32 s87, s87, s92
    s_lshl_b32 s88, s77, 5
    s_add_u32 s88, s88, s92
    s_lshl_b32 s89, s78, 5
    s_add_u32 s89, s89, s92
    s_lshl_b32 s90, s79, 5
    s_add_u32 s90, s90, s92
    s_lshl_b32 s91, s80, 5
    s_add_u32 s91, s91, s92
    v_add_u32 v28, 28672, v16
    s_add_u32 s71, s65, 12288
    v_add_u32 v29, s71, v16
    s_xor_b32 s71, s64, 2
    s_mul_i32 s71, s71, 40960
    s_add_u32 s71, s71, 12288
    v_add_u32 v27, s71, v16
    v_bfe_u32 v251, v1, 4, 1
    v_lshrrev_b32 v253, 5, v1
    v_lshl_add_u32 v26, v251, 5, v26
    v_lshl_add_u32 v26, v253, 4, v26
    v_and_b32 v252, 15, v1
    v_bfe_u32 v254, v1, 1, 2
    v_xor_b32 v254, v254, v253
    v_lshlrev_b32 v254, 4, v254
    v_lshl_add_u32 v254, v251, 3, v254
    v_lshl_add_u32 v254, v252, 6, v254
    s_add_u32 s71, s65, 38912
    v_add_u32 v4, s71, v254
    v_xor_b32 v5, 32, v4
    v_bfe_u32 v254, v1, 3, 2
    v_lshlrev_b32 v254, 4, v254
    v_xor_b32 v254, v254, v16
    v_add_u32 v6, s71, v254
    v_lshrrev_b32 v252, 2, v1
    v_and_b32 v254, 3, v1
    v_mul_u32_u24 v252, 896, v252
    v_lshl_add_u32 v26, v254, 4, v252
    s_waitcnt vmcnt(0)
    s_barrier
    s_mov_b32 exec_hi, 0
    buffer_store_dword v3, v17, s[36:39], s20 offen sc1
    s_mov_b32 exec_hi, -1
    s_add_u32 m0, s65, 0
    s_mul_i32 s73, s78, 896
    buffer_load_dwordx4 v214, s[32:35], s73 offen offset:0 lds
    buffer_load_dwordx4 v215, s[32:35], s73 offen offset:1024 lds
    buffer_load_dwordx4 v216, s[32:35], s73 offen offset:2048 lds
    buffer_load_dwordx4 v217, s[32:35], s73 offen offset:3072 lds
    s_add_u32 m0, s65, 4096
    s_mul_i32 s73, s79, 896
    buffer_load_dwordx4 v214, s[32:35], s73 offen offset:0 lds
    buffer_load_dwordx4 v215, s[32:35], s73 offen offset:1024 lds
    buffer_load_dwordx4 v216, s[32:35], s73 offen offset:2048 lds
    buffer_load_dwordx4 v217, s[32:35], s73 offen offset:3072 lds
    s_add_u32 m0, s65, 8192
    s_mul_i32 s73, s80, 896
    buffer_load_dwordx4 v214, s[32:35], s73 offen offset:0 lds
    buffer_load_dwordx4 v215, s[32:35], s73 offen offset:1024 lds
    buffer_load_dwordx4 v216, s[32:35], s73 offen offset:2048 lds
    buffer_load_dwordx4 v217, s[32:35], s73 offen offset:3072 lds
    ds_read_b64 v[112:113], v24 offset:0
    ds_read_b64 v[114:115], v24 offset:40960
    ds_read_b64 v[116:117], v25 offset:0
    ds_read_b64 v[118:119], v25 offset:40960
    s_waitcnt lgkmcnt(4)
    v_lshlrev_b32 v144, 16, v64
    v_and_b32 v145, 0xffff0000, v64
    v_lshlrev_b32 v146, 16, v65
    v_and_b32 v147, 0xffff0000, v65
    v_lshlrev_b32 v148, 16, v66
    v_and_b32 v149, 0xffff0000, v66
    v_lshlrev_b32 v150, 16, v67
    v_and_b32 v151, 0xffff0000, v67
    v_lshlrev_b32 v152, 16, v68
    v_and_b32 v153, 0xffff0000, v68
    v_lshlrev_b32 v154, 16, v69
    v_and_b32 v155, 0xffff0000, v69
    v_lshlrev_b32 v156, 16, v70
    v_and_b32 v157, 0xffff0000, v70
    v_lshlrev_b32 v158, 16, v71
    v_and_b32 v159, 0xffff0000, v71
    s_waitcnt lgkmcnt(0)
    v_lshlrev_b32 v128, 16, v112
    v_and_b32 v129, 0xffff0000, v112
    v_lshlrev_b32 v130, 16, v113
    v_and_b32 v131, 0xffff0000, v113
    v_pk_mul_f32 v[128:129], v[128:129], v[244:245] op_sel_hi:[1,0]
    v_pk_mul_f32 v[130:131], v[130:131], v[244:245] op_sel_hi:[1,0]
    v_lshlrev_b32 v132, 16, v114
    v_and_b32 v133, 0xffff0000, v114
    v_lshlrev_b32 v134, 16, v115
    v_and_b32 v135, 0xffff0000, v115
    v_pk_mul_f32 v[132:133], v[132:133], v[246:247] op_sel_hi:[1,0]
    v_pk_mul_f32 v[134:135], v[134:135], v[246:247] op_sel_hi:[1,0]
    v_lshlrev_b32 v136, 16, v116
    v_and_b32 v137, 0xffff0000, v116
    v_lshlrev_b32 v138, 16, v117
    v_and_b32 v139, 0xffff0000, v117
    v_pk_mul_f32 v[136:137], v[136:137], v[244:245] op_sel_hi:[1,0]
    v_pk_mul_f32 v[138:139], v[138:139], v[244:245] op_sel_hi:[1,0]
    v_lshlrev_b32 v140, 16, v118
    v_and_b32 v141, 0xffff0000, v118
    v_lshlrev_b32 v142, 16, v119
    v_and_b32 v143, 0xffff0000, v119
    v_pk_mul_f32 v[140:141], v[140:141], v[246:247] op_sel_hi:[1,0]
    v_pk_mul_f32 v[142:143], v[142:143], v[246:247] op_sel_hi:[1,0]
    v_sub_f32 v244, 1.0, v244
    v_sub_f32 v246, 1.0, v246
    v_pk_mul_f32 v[144:145], v[144:145], v[128:129]
    v_pk_mul_f32 v[146:147], v[146:147], v[130:131]
    v_pk_mul_f32 v[148:149], v[148:149], v[132:133]
    v_pk_mul_f32 v[150:151], v[150:151], v[134:135]
    v_pk_mul_f32 v[152:153], v[152:153], v[136:137]
    v_pk_mul_f32 v[154:155], v[154:155], v[138:139]
    v_pk_mul_f32 v[156:157], v[156:157], v[140:141]
    v_pk_mul_f32 v[158:159], v[158:159], v[142:143]
    s_waitcnt vmcnt(12)
    buffer_load_dword v227, v225, s[36:39], s22 offen sc1
    s_waitcnt vmcnt(0)
    v_cmp_ne_u32 vcc, s15, v227
    s_nop 0
    s_cmp_lg_u64 vcc, 0
    s_cbranch_scc1 L_slow_9
L_back_10:
    s_barrier
    buffer_load_dwordx4 a[0:3], v16, s[36:39], s85 offen offset:0 sc1
    buffer_load_dwordx4 a[4:7], v28, s[36:39], s85 offen offset:0 sc1
    buffer_load_dwordx4 a[8:11], v16, s[36:39], s85 offen offset:1024 sc1
    buffer_load_dwordx4 a[12:15], v28, s[36:39], s85 offen offset:1024 sc1
    buffer_load_dwordx4 a[16:19], v16, s[36:39], s86 offen offset:0 sc1
    buffer_load_dwordx4 a[20:23], v28, s[36:39], s86 offen offset:0 sc1
    buffer_load_dwordx4 a[24:27], v16, s[36:39], s86 offen offset:1024 sc1
    buffer_load_dwordx4 a[28:31], v28, s[36:39], s86 offen offset:1024 sc1
    buffer_load_dwordx4 a[32:35], v16, s[36:39], s87 offen offset:0 sc1
    buffer_load_dwordx4 a[36:39], v28, s[36:39], s87 offen offset:0 sc1
    ds_read_b64_tr_b16 v[160:161], v72 offset:20480
    ds_read_b64_tr_b16 v[162:163], v76 offset:20480
    ds_read_b64_tr_b16 v[164:165], v73 offset:20480
    ds_read_b64_tr_b16 v[166:167], v77 offset:20480
    ds_read_b64_tr_b16 v[168:169], v74 offset:20480
    ds_read_b64_tr_b16 v[170:171], v78 offset:20480
    ds_read_b64_tr_b16 v[172:173], v75 offset:20480
    ds_read_b64_tr_b16 v[174:175], v79 offset:20480
    ds_read_b64_tr_b16 v[176:177], v72 offset:21504
    ds_read_b64_tr_b16 v[178:179], v76 offset:21504
    ds_read_b64_tr_b16 v[180:181], v73 offset:21504
    ds_read_b64_tr_b16 v[182:183], v77 offset:21504
    ds_read_b64_tr_b16 v[184:185], v74 offset:21504
    ds_read_b64_tr_b16 v[186:187], v78 offset:21504
    ds_read_b64_tr_b16 v[188:189], v75 offset:21504
    ds_read_b64_tr_b16 v[190:191], v79 offset:21504
    s_waitcnt vmcnt(8) lgkmcnt(8)
    v_mfma_f32_16x16x32_bf16 v[48:51], v[168:171], a[0:3], 0
    ds_read_b64_tr_b16 v[192:193], v72 offset:24576
    v_mfma_f32_16x16x32_bf16 v[52:55], v[168:171], a[4:7], 0
    ds_read_b64_tr_b16 v[194:195], v76 offset:24576
    buffer_load_dwordx4 a[40:43], v16, s[36:39], s87 offen offset:1024 sc1
    v_mfma_f32_16x16x32_bf16 v[56:59], v[172:175], a[0:3], 0
    ds_read_b64_tr_b16 v[196:197], v73 offset:24576
    v_mfma_f32_16x16x32_bf16 v[60:63], v[172:175], a[4:7], 0
    ds_read_b64_tr_b16 v[198:199], v77 offset:24576
    v_mfma_f32_16x16x32_bf16 v[32:35], v[160:163], a[0:3], 0
    ds_read_b64_tr_b16 v[200:201], v74 offset:24576
    v_mfma_f32_16x16x32_bf16 v[36:39], v[160:163], a[4:7], 0
    ds_read_b64_tr_b16 v[202:203], v78 offset:24576
    buffer_load_dwordx4 a[44:47], v28, s[36:39], s87 offen offset:1024 sc1
    v_mfma_f32_16x16x32_bf16 v[40:43], v[164:167], a[0:3], 0
    ds_read_b64_tr_b16 v[204:205], v75 offset:24576
    v_mfma_f32_16x16x32_bf16 v[44:47], v[164:167], a[4:7], 0
    ds_read_b64_tr_b16 v[206:207], v79 offset:24576
    s_waitcnt vmcnt(8) lgkmcnt(8)
    v_mfma_f32_16x16x32_bf16 v[48:51], v[184:187], a[8:11], v[48:51]
    ds_read_b64_tr_b16 v[160:161], v72 offset:25600
    v_mfma_f32_16x16x32_bf16 v[52:55], v[184:187], a[12:15], v[52:55]
    ds_read_b64_tr_b16 v[162:163], v76 offset:25600
    buffer_load_dwordx4 a[48:51], v16, s[36:39], s88 offen offset:0 sc1
    v_mfma_f32_16x16x32_bf16 v[56:59], v[188:191], a[8:11], v[56:59]
    ds_read_b64_tr_b16 v[164:165], v73 offset:25600
    v_mfma_f32_16x16x32_bf16 v[60:63], v[188:191], a[12:15], v[60:63]
    ds_read_b64_tr_b16 v[166:167], v77 offset:25600
    v_mfma_f32_16x16x32_bf16 v[32:35], v[176:179], a[8:11], v[32:35]
    ds_read_b64_tr_b16 v[168:169], v74 offset:25600
    v_mfma_f32_16x16x32_bf16 v[36:39], v[176:179], a[12:15], v[36:39]
    ds_read_b64_tr_b16 v[170:171], v78 offset:25600
    buffer_load_dwordx4 a[52:55], v28, s[36:39], s88 offen offset:0 sc1
    v_mfma_f32_16x16x32_bf16 v[40:43], v[180:183], a[8:11], v[40:43]
    ds_read_b64_tr_b16 v[172:173], v75 offset:25600
    v_mfma_f32_16x16x32_bf16 v[44:47], v[180:183], a[12:15], v[44:47]
    ds_read_b64_tr_b16 v[174:175], v79 offset:25600
    s_waitcnt vmcnt(8) lgkmcnt(8)
    v_mfma_f32_16x16x32_bf16 v[48:51], v[200:203], a[16:19], v[48:51]
    ds_read_b64_tr_b16 v[176:177], v72 offset:28672
    v_mfma_f32_16x16x32_bf16 v[52:55], v[200:203], a[20:23], v[52:55]
    ds_read_b64_tr_b16 v[178:179], v76 offset:28672
    buffer_load_dwordx4 a[56:59], v16, s[36:39], s88 offen offset:1024 sc1
    v_mfma_f32_16x16x32_bf16 v[56:59], v[204:207], a[16:19], v[56:59]
    ds_read_b64_tr_b16 v[180:181], v73 offset:28672
    v_mfma_f32_16x16x32_bf16 v[60:63], v[204:207], a[20:23], v[60:63]
    ds_read_b64_tr_b16 v[182:183], v77 offset:28672
    v_mfma_f32_16x16x32_bf16 v[32:35], v[192:195], a[16:19], v[32:35]
    ds_read_b64_tr_b16 v[184:185], v74 offset:28672
    v_mfma_f32_16x16x32_bf16 v[36:39], v[192:195], a[20:23], v[36:39]
    ds_read_b64_tr_b16 v[186:187], v78 offset:28672
    buffer_load_dwordx4 a[60:63], v28, s[36:39], s88 offen offset:1024 sc1
    v_mfma_f32_16x16x32_bf16 v[40:43], v[196:199], a[16:19], v[40:43]
    ds_read_b64_tr_b16 v[188:189], v75 offset:28672
    v_mfma_f32_16x16x32_bf16 v[44:47], v[196:199], a[20:23], v[44:47]
    ds_read_b64_tr_b16 v[190:191], v79 offset:28672
    s_waitcnt vmcnt(8) lgkmcnt(8)
    v_mfma_f32_16x16x32_bf16 v[48:51], v[168:171], a[24:27], v[48:51]
    ds_read_b64_tr_b16 v[192:193], v72 offset:29696
    v_mfma_f32_16x16x32_bf16 v[52:55], v[168:171], a[28:31], v[52:55]
    ds_read_b64_tr_b16 v[194:195], v76 offset:29696
    buffer_load_dwordx4 a[64:67], v16, s[36:39], s89 offen offset:0 sc1
    v_mfma_f32_16x16x32_bf16 v[56:59], v[172:175], a[24:27], v[56:59]
    ds_read_b64_tr_b16 v[196:197], v73 offset:29696
    v_mfma_f32_16x16x32_bf16 v[60:63], v[172:175], a[28:31], v[60:63]
    ds_read_b64_tr_b16 v[198:199], v77 offset:29696
    v_mfma_f32_16x16x32_bf16 v[32:35], v[160:163], a[24:27], v[32:35]
    ds_read_b64_tr_b16 v[200:201], v74 offset:29696
    v_mfma_f32_16x16x32_bf16 v[36:39], v[160:163], a[28:31], v[36:39]
    ds_read_b64_tr_b16 v[202:203], v78 offset:29696
    buffer_load_dwordx4 a[68:71], v28, s[36:39], s89 offen offset:0 sc1
    v_mfma_f32_16x16x32_bf16 v[40:43], v[164:167], a[24:27], v[40:43]
    ds_read_b64_tr_b16 v[204:205], v75 offset:29696
    v_mfma_f32_16x16x32_bf16 v[44:47], v[164:167], a[28:31], v[44:47]
    ds_read_b64_tr_b16 v[206:207], v79 offset:29696
    buffer_load_dword v18, v245, s[36:39], 0 offen sc1
    s_waitcnt vmcnt(9) lgkmcnt(8)
    v_mfma_f32_16x16x32_bf16 v[48:51], v[184:187], a[32:35], v[48:51]
    ds_read_b64_tr_b16 v[160:161], v72 offset:32768
    v_mfma_f32_16x16x32_bf16 v[52:55], v[184:187], a[36:39], v[52:55]
    ds_read_b64_tr_b16 v[162:163], v76 offset:32768
    buffer_load_dwordx4 a[72:75], v16, s[36:39], s89 offen offset:1024 sc1
    v_mfma_f32_16x16x32_bf16 v[56:59], v[188:191], a[32:35], v[56:59]
    ds_read_b64_tr_b16 v[164:165], v73 offset:32768
    v_mfma_f32_16x16x32_bf16 v[60:63], v[188:191], a[36:39], v[60:63]
    ds_read_b64_tr_b16 v[166:167], v77 offset:32768
    v_mfma_f32_16x16x32_bf16 v[32:35], v[176:179], a[32:35], v[32:35]
    ds_read_b64_tr_b16 v[168:169], v74 offset:32768
    v_mfma_f32_16x16x32_bf16 v[36:39], v[176:179], a[36:39], v[36:39]
    ds_read_b64_tr_b16 v[170:171], v78 offset:32768
    buffer_load_dwordx4 a[76:79], v28, s[36:39], s89 offen offset:1024 sc1
    v_mfma_f32_16x16x32_bf16 v[40:43], v[180:183], a[32:35], v[40:43]
    ds_read_b64_tr_b16 v[172:173], v75 offset:32768
    v_mfma_f32_16x16x32_bf16 v[44:47], v[180:183], a[36:39], v[44:47]
    ds_read_b64_tr_b16 v[174:175], v79 offset:32768
    s_waitcnt vmcnt(9) lgkmcnt(8)
    v_mfma_f32_16x16x32_bf16 v[48:51], v[200:203], a[40:43], v[48:51]
    ds_read_b64_tr_b16 v[176:177], v72 offset:33792
    v_mfma_f32_16x16x32_bf16 v[52:55], v[200:203], a[44:47], v[52:55]
    ds_read_b64_tr_b16 v[178:179], v76 offset:33792
    buffer_load_dwordx4 a[80:83], v16, s[36:39], s90 offen offset:0 sc1
    v_mfma_f32_16x16x32_bf16 v[56:59], v[204:207], a[40:43], v[56:59]
    ds_read_b64_tr_b16 v[180:181], v73 offset:33792
    v_mfma_f32_16x16x32_bf16 v[60:63], v[204:207], a[44:47], v[60:63]
    ds_read_b64_tr_b16 v[182:183], v77 offset:33792
    v_mfma_f32_16x16x32_bf16 v[32:35], v[192:195], a[40:43], v[32:35]
    ds_read_b64_tr_b16 v[184:185], v74 offset:33792
    v_mfma_f32_16x16x32_bf16 v[36:39], v[192:195], a[44:47], v[36:39]
    ds_read_b64_tr_b16 v[186:187], v78 offset:33792
    buffer_load_dwordx4 a[84:87], v28, s[36:39], s90 offen offset:0 sc1
    v_mfma_f32_16x16x32_bf16 v[40:43], v[196:199], a[40:43], v[40:43]
    ds_read_b64_tr_b16 v[188:189], v75 offset:33792
    v_mfma_f32_16x16x32_bf16 v[44:47], v[196:199], a[44:47], v[44:47]
    ds_read_b64_tr_b16 v[190:191], v79 offset:33792
    s_waitcnt vmcnt(9) lgkmcnt(8)
    v_mfma_f32_16x16x32_bf16 v[48:51], v[168:171], a[48:51], v[48:51]
    ds_read_b64_tr_b16 v[192:193], v72 offset:0
    v_mfma_f32_16x16x32_bf16 v[52:55], v[168:171], a[52:55], v[52:55]
    ds_read_b64_tr_b16 v[194:195], v76 offset:0
    buffer_load_dwordx4 a[88:91], v16, s[36:39], s90 offen offset:1024 sc1
    v_mfma_f32_16x16x32_bf16 v[56:59], v[172:175], a[48:51], v[56:59]
    ds_read_b64_tr_b16 v[196:197], v73 offset:0
    v_mfma_f32_16x16x32_bf16 v[60:63], v[172:175], a[52:55], v[60:63]
    ds_read_b64_tr_b16 v[198:199], v77 offset:0
    v_mfma_f32_16x16x32_bf16 v[32:35], v[160:163], a[48:51], v[32:35]
L_pad6:
    s_cbranch_execz L_hop2
    ds_read_b64_tr_b16 v[200:201], v74 offset:0
    v_mfma_f32_16x16x32_bf16 v[36:39], v[160:163], a[52:55], v[36:39]
    ds_read_b64_tr_b16 v[202:203], v78 offset:0
    buffer_load_dwordx4 a[92:95], v28, s[36:39], s90 offen offset:1024 sc1
    v_mfma_f32_16x16x32_bf16 v[40:43], v[164:167], a[48:51], v[40:43]
    ds_read_b64_tr_b16 v[204:205], v75 offset:0
    v_mfma_f32_16x16x32_bf16 v[44:47], v[164:167], a[52:55], v[44:47]
    ds_read_b64_tr_b16 v[206:207], v79 offset:0
    s_waitcnt vmcnt(9) lgkmcnt(8)
    v_mfma_f32_16x16x32_bf16 v[48:51], v[184:187], a[56:59], v[48:51]
    ds_read_b64_tr_b16 v[160:161], v72 offset:1024
    v_mfma_f32_16x16x32_bf16 v[52:55], v[184:187], a[60:63], v[52:55]
    ds_read_b64_tr_b16 v[162:163], v76 offset:1024
    buffer_load_dwordx4 a[96:99], v16, s[36:39], s91 offen offset:0 sc1
    v_mfma_f32_16x16x32_bf16 v[56:59], v[188:191], a[56:59], v[56:59]
    ds_read_b64_tr_b16 v[164:165], v73 offset:1024
    v_mfma_f32_16x16x32_bf16 v[60:63], v[188:191], a[60:63], v[60:63]
    ds_read_b64_tr_b16 v[166:167], v77 offset:1024
    v_mfma_f32_16x16x32_bf16 v[32:35], v[176:179], a[56:59], v[32:35]
    ds_read_b64_tr_b16 v[168:169], v74 offset:1024
    v_mfma_f32_16x16x32_bf16 v[36:39], v[176:179], a[60:63], v[36:39]
    ds_read_b64_tr_b16 v[170:171], v78 offset:1024
    buffer_load_dwordx4 a[100:103], v28, s[36:39], s91 offen offset:0 sc1
    v_mfma_f32_16x16x32_bf16 v[40:43], v[180:183], a[56:59], v[40:43]
    ds_read_b64_tr_b16 v[172:173], v75 offset:1024
    v_mfma_f32_16x16x32_bf16 v[44:47], v[180:183], a[60:63], v[44:47]
    ds_read_b64_tr_b16 v[174:175], v79 offset:1024
    s_waitcnt vmcnt(9) lgkmcnt(8)
    v_mfma_f32_16x16x32_bf16 v[48:51], v[200:203], a[64:67], v[48:51]
    ds_read_b64_tr_b16 v[176:177], v72 offset:4096
    v_mfma_f32_16x16x32_bf16 v[52:55], v[200:203], a[68:71], v[52:55]
    ds_read_b64_tr_b16 v[178:179], v76 offset:4096
    buffer_load_dwordx4 a[104:107], v16, s[36:39], s91 offen offset:1024 sc1
    v_mfma_f32_16x16x32_bf16 v[56:59], v[204:207], a[64:67], v[56:59]
    ds_read_b64_tr_b16 v[180:181], v73 offset:4096
    v_mfma_f32_16x16x32_bf16 v[60:63], v[204:207], a[68:71], v[60:63]
    ds_read_b64_tr_b16 v[182:183], v77 offset:4096
    v_mfma_f32_16x16x32_bf16 v[32:35], v[192:195], a[64:67], v[32:35]
    ds_read_b64_tr_b16 v[184:185], v74 offset:4096
    v_mfma_f32_16x16x32_bf16 v[36:39], v[192:195], a[68:71], v[36:39]
    ds_read_b64_tr_b16 v[186:187], v78 offset:4096
    buffer_load_dwordx4 a[108:111], v28, s[36:39], s91 offen offset:1024 sc1
    v_mfma_f32_16x16x32_bf16 v[40:43], v[196:199], a[64:67], v[40:43]
    ds_read_b64_tr_b16 v[188:189], v75 offset:4096
    v_mfma_f32_16x16x32_bf16 v[44:47], v[196:199], a[68:71], v[44:47]
    ds_read_b64_tr_b16 v[190:191], v79 offset:4096
    s_waitcnt vmcnt(8) lgkmcnt(8)
    v_cmp_ne_u32 vcc, s66, v18
    s_nop 0
    s_cmp_lg_u64 vcc, 0
    s_cbranch_scc1 L_slow_11
L_back_12:
    s_add_u32 m0, s65, 16384
    s_nop 0
    buffer_load_dwordx4 v20, s[36:39], s81 offen sc1 lds
    buffer_load_dwordx4 v21, s[36:39], s81 offen offset:1024 sc1 lds
    v_mfma_f32_16x16x32_bf16 v[48:51], v[168:171], a[72:75], v[48:51]
    ds_read_b64_tr_b16 v[192:193], v72 offset:5120
    v_mfma_f32_16x16x32_bf16 v[52:55], v[168:171], a[76:79], v[52:55]
    ds_read_b64_tr_b16 v[194:195], v76 offset:5120
    v_mfma_f32_16x16x32_bf16 v[56:59], v[172:175], a[72:75], v[56:59]
    ds_read_b64_tr_b16 v[196:197], v73 offset:5120
    v_mfma_f32_16x16x32_bf16 v[60:63], v[172:175], a[76:79], v[60:63]
    ds_read_b64_tr_b16 v[198:199], v77 offset:5120
    v_mfma_f32_16x16x32_bf16 v[32:35], v[160:163], a[72:75], v[32:35]
    ds_read_b64_tr_b16 v[200:201], v74 offset:5120
    v_mfma_f32_16x16x32_bf16 v[36:39], v[160:163], a[76:79], v[36:39]
    ds_read_b64_tr_b16 v[202:203], v78 offset:5120
    v_mfma_f32_16x16x32_bf16 v[40:43], v[164:167], a[72:75], v[40:43]
    ds_read_b64_tr_b16 v[204:205], v75 offset:5120
    v_mfma_f32_16x16x32_bf16 v[44:47], v[164:167], a[76:79], v[44:47]
    ds_read_b64_tr_b16 v[206:207], v79 offset:5120
    s_waitcnt vmcnt(8) lgkmcnt(8)
    v_mfma_f32_16x16x32_bf16 v[48:51], v[184:187], a[80:83], v[48:51]
    ds_read_b64_tr_b16 v[160:161], v72 offset:8192
    v_mfma_f32_16x16x32_bf16 v[52:55], v[184:187], a[84:87], v[52:55]
    ds_read_b64_tr_b16 v[162:163], v76 offset:8192
    v_mfma_f32_16x16x32_bf16 v[56:59], v[188:191], a[80:83], v[56:59]
    ds_read_b64_tr_b16 v[164:165], v73 offset:8192
    v_mfma_f32_16x16x32_bf16 v[60:63], v[188:191], a[84:87], v[60:63]
    ds_read_b64_tr_b16 v[166:167], v77 offset:8192
    v_mfma_f32_16x16x32_bf16 v[32:35], v[176:179], a[80:83], v[32:35]
    ds_read_b64_tr_b16 v[168:169], v74 offset:8192
    v_mfma_f32_16x16x32_bf16 v[36:39], v[176:179], a[84:87], v[36:39]
    ds_read_b64_tr_b16 v[170:171], v78 offset:8192
    v_mfma_f32_16x16x32_bf16 v[40:43], v[180:183], a[80:83], v[40:43]
    ds_read_b64_tr_b16 v[172:173], v75 offset:8192
    v_mfma_f32_16x16x32_bf16 v[44:47], v[180:183], a[84:87], v[44:47]
    ds_read_b64_tr_b16 v[174:175], v79 offset:8192
    s_waitcnt vmcnt(6) lgkmcnt(8)
    v_mfma_f32_16x16x32_bf16 v[48:51], v[200:203], a[88:91], v[48:51]
    ds_read_b64_tr_b16 v[176:177], v72 offset:9216
    v_mfma_f32_16x16x32_bf16 v[52:55], v[200:203], a[92:95], v[52:55]
    ds_read_b64_tr_b16 v[178:179], v76 offset:9216
    v_mfma_f32_16x16x32_bf16 v[56:59], v[204:207], a[88:91], v[56:59]
    ds_read_b64_tr_b16 v[180:181], v73 offset:9216
    v_mfma_f32_16x16x32_bf16 v[60:63], v[204:207], a[92:95], v[60:63]
    ds_read_b64_tr_b16 v[182:183], v77 offset:9216
    v_mfma_f32_16x16x32_bf16 v[32:35], v[192:195], a[88:91], v[32:35]
    ds_read_b64_tr_b16 v[184:185], v74 offset:9216
    v_mfma_f32_16x16x32_bf16 v[36:39], v[192:195], a[92:95], v[36:39]
    ds_read_b64_tr_b16 v[186:187], v78 offset:9216
    v_mfma_f32_16x16x32_bf16 v[40:43], v[196:199], a[88:91], v[40:43]
    ds_read_b64_tr_b16 v[188:189], v75 offset:9216
    v_mfma_f32_16x16x32_bf16 v[44:47], v[196:199], a[92:95], v[44:47]
    ds_read_b64_tr_b16 v[190:191], v79 offset:9216
    s_waitcnt vmcnt(4) lgkmcnt(8)
    v_mfma_f32_16x16x32_bf16 v[48:51], v[168:171], a[96:99], v[48:51]
    v_mfma_f32_16x16x32_bf16 v[52:55], v[168:171], a[100:103], v[52:55]
    v_mfma_f32_16x16x32_bf16 v[56:59], v[172:175], a[96:99], v[56:59]
    v_mfma_f32_16x16x32_bf16 v[60:63], v[172:175], a[100:103], v[60:63]
    v_mfma_f32_16x16x32_bf16 v[32:35], v[160:163], a[96:99], v[32:35]
    v_mfma_f32_16x16x32_bf16 v[36:39], v[160:163], a[100:103], v[36:39]
    v_mfma_f32_16x16x32_bf16 v[40:43], v[164:167], a[96:99], v[40:43]
    v_mfma_f32_16x16x32_bf16 v[44:47], v[164:167], a[100:103], v[44:47]
    s_waitcnt vmcnt(2) lgkmcnt(0)
    v_mfma_f32_16x16x32_bf16 v[48:51], v[184:187], a[104:107], v[48:51]
    v_mfma_f32_16x16x32_bf16 v[52:55], v[184:187], a[108:111], v[52:55]
    v_mfma_f32_16x16x32_bf16 v[56:59], v[188:191], a[104:107], v[56:59]
    v_mfma_f32_16x16x32_bf16 v[60:63], v[188:191], a[108:111], v[60:63]
    v_mfma_f32_16x16x32_bf16 v[32:35], v[176:179], a[104:107], v[32:35]
    v_mfma_f32_16x16x32_bf16 v[36:39], v[176:179], a[108:111], v[36:39]
    v_mfma_f32_16x16x32_bf16 v[40:43], v[180:183], a[104:107], v[40:43]
    v_mfma_f32_16x16x32_bf16 v[44:47], v[180:183], a[108:111], v[44:47]
    s_nop 0
    ds_write_b128 v29, v[48:51] offset:0
    ds_write_b128 v29, v[52:55] offset:1024
    ds_write_b128 v29, v[56:59] offset:2048
    ds_write_b128 v29, v[60:63] offset:3072
    v_pk_fma_f32 v[144:145], v[32:33], v[244:245], v[144:145] op_sel_hi:[1,0,1]
    v_pk_fma_f32 v[146:147], v[34:35], v[244:245], v[146:147] op_sel_hi:[1,0,1]
    v_pk_fma_f32 v[148:149], v[36:37], v[246:247], v[148:149] op_sel_hi:[1,0,1]
    v_pk_fma_f32 v[150:151], v[38:39], v[246:247], v[150:151] op_sel_hi:[1,0,1]
    v_pk_fma_f32 v[152:153], v[40:41], v[244:245], v[152:153] op_sel_hi:[1,0,1]
    v_pk_fma_f32 v[154:155], v[42:43], v[244:245], v[154:155] op_sel_hi:[1,0,1]
    v_pk_fma_f32 v[156:157], v[44:45], v[246:247], v[156:157] op_sel_hi:[1,0,1]
    v_pk_fma_f32 v[158:159], v[46:47], v[246:247], v[158:159] op_sel_hi:[1,0,1]
    s_waitcnt vmcnt(0) lgkmcnt(0)
    s_barrier
    ds_read_b64_tr_b16 v[120:121], v14 offset:0
    ds_read_b64_tr_b16 v[122:123], v15 offset:0
    ds_read_b64_tr_b16 v[124:125], v14 offset:40960
    ds_read_b64_tr_b16 v[126:127], v15 offset:40960
    ds_read_b128 v[160:163], v27 offset:0
    ds_read_b128 v[168:171], v27 offset:2048
    ds_read_b128 v[164:167], v27 offset:1024
    ds_read_b128 v[172:175], v27 offset:3072
    s_waitcnt lgkmcnt(4)
    v_lshlrev_b32 v80, 16, v120
    v_and_b32 v81, 0xffff0000, v120
    v_lshlrev_b32 v82, 16, v121
    v_and_b32 v83, 0xffff0000, v121
    v_lshlrev_b32 v84, 16, v122
    v_and_b32 v85, 0xffff0000, v122
    v_lshlrev_b32 v86, 16, v123
    v_and_b32 v87, 0xffff0000, v123
    v_lshlrev_b32 v88, 16, v124
    v_and_b32 v89, 0xffff0000, v124
    v_lshlrev_b32 v90, 16, v125
    v_and_b32 v91, 0xffff0000, v125
    v_lshlrev_b32 v92, 16, v126
    v_and_b32 v93, 0xffff0000, v126
    v_lshlrev_b32 v94, 16, v127
    v_and_b32 v95, 0xffff0000, v127
    v_pk_fma_f32 v[128:129], v[128:129], v[80:81], v[144:145]
    v_pk_fma_f32 v[130:131], v[130:131], v[82:83], v[146:147]
    v_pk_fma_f32 v[132:133], v[132:133], v[84:85], v[148:149]
    v_pk_fma_f32 v[134:135], v[134:135], v[86:87], v[150:151]
    v_pk_fma_f32 v[136:137], v[136:137], v[88:89], v[152:153]
    v_pk_fma_f32 v[138:139], v[138:139], v[90:91], v[154:155]
    v_pk_fma_f32 v[140:141], v[140:141], v[92:93], v[156:157]
    v_pk_fma_f32 v[142:143], v[142:143], v[94:95], v[158:159]
    s_waitcnt lgkmcnt(2)
    v_pk_fma_f32 v[160:161], v[160:161], v[244:245], v[128:129] op_sel_hi:[1,0,1]
    v_pk_fma_f32 v[162:163], v[162:163], v[244:245], v[130:131] op_sel_hi:[1,0,1]
    v_cvt_pk_bf16_f32 v64, v160, v161
    v_cvt_pk_bf16_f32 v65, v162, v163
    v_pk_fma_f32 v[168:169], v[168:169], v[244:245], v[136:137] op_sel_hi:[1,0,1]
    v_pk_fma_f32 v[170:171], v[170:171], v[244:245], v[138:139] op_sel_hi:[1,0,1]
    v_cvt_pk_bf16_f32 v66, v168, v169
    v_cvt_pk_bf16_f32 v67, v170, v171
    ds_write_b64 v4, v[64:65] offset:0
    ds_write_b64 v5, v[66:67] offset:0
    ds_read_b128 v[72:75], v6 offset:0
    s_waitcnt lgkmcnt(3)
    v_pk_fma_f32 v[164:165], v[164:165], v[246:247], v[132:133] op_sel_hi:[1,0,1]
    v_pk_fma_f32 v[166:167], v[166:167], v[246:247], v[134:135] op_sel_hi:[1,0,1]
    v_cvt_pk_bf16_f32 v68, v164, v165
    v_cvt_pk_bf16_f32 v69, v166, v167
    v_pk_fma_f32 v[172:173], v[172:173], v[246:247], v[140:141] op_sel_hi:[1,0,1]
    v_pk_fma_f32 v[174:175], v[174:175], v[246:247], v[142:143] op_sel_hi:[1,0,1]
    v_cvt_pk_bf16_f32 v70, v172, v173
    v_cvt_pk_bf16_f32 v71, v174, v175
    ds_write_b64 v4, v[68:69] offset:1024
    ds_write_b64 v5, v[70:71] offset:1024
    ds_read_b128 v[76:79], v6 offset:1024
    s_waitcnt lgkmcnt(3)
    buffer_store_dwordx4 v[72:75], v26, s[40:43], s72 offen
    s_waitcnt lgkmcnt(0)
    buffer_store_dwordx4 v[76:79], v26, s[40:43], s83 offen
    s_endpgm
L_slow_1:
    s_nop 7
    s_mov_b32 s71, 20000
L_poll_13:
    buffer_load_dword v144, v17, s[36:39], s72 offen offset:0 sc1
    buffer_load_dword v145, v17, s[36:39], s72 offen offset:256 sc1
    buffer_load_dword v146, v17, s[36:39], s72 offen offset:512 sc1
    buffer_load_dword v147, v17, s[36:39], s72 offen offset:768 sc1
    buffer_load_dword v148, v17, s[36:39], s72 offen offset:1024 sc1
    buffer_load_dword v149, v17, s[36:39], s72 offen offset:1280 sc1
    buffer_load_dword v150, v17, s[36:39], s72 offen offset:1536 sc1
    buffer_load_dword v151, v17, s[36:39], s72 offen offset:1792 sc1
    buffer_load_dword v152, v17, s[36:39], s72 offen offset:2048 sc1
    buffer_load_dword v153, v17, s[36:39], s72 offen offset:2304 sc1
    buffer_load_dword v154, v17, s[36:39], s72 offen offset:2560 sc1
    buffer_load_dword v155, v17, s[36:39], s72 offen offset:2816 sc1
    buffer_load_dword v156, v17, s[36:39], s72 offen offset:3072 sc1
    buffer_load_dword v157, v17, s[36:39], s72 offen offset:3328 sc1
    s_waitcnt vmcnt(0)
    v_xor_b32 v144, v30, v144
    v_xor_b32 v145, v30, v145
    v_xor_b32 v146, v30, v146
    v_xor_b32 v147, v30, v147
    v_xor_b32 v148, v30, v148
    v_xor_b32 v149, v30, v149
    v_xor_b32 v150, v30, v150
    v_xor_b32 v151, v30, v151
    v_xor_b32 v152, v30, v152
    v_xor_b32 v153, v30, v153
    v_xor_b32 v154, v30, v154
    v_xor_b32 v155, v30, v155
    v_xor_b32 v156, v30, v156
    v_xor_b32 v157, v30, v157
    v_or_b32 v248, v144, v145
    v_or3_b32 v248, v248, v146, v147
    v_or3_b32 v248, v248, v148, v149
    v_or3_b32 v248, v248, v150, v151
    v_or3_b32 v248, v248, v152, v153
    v_or3_b32 v248, v248, v154, v155
    v_or3_b32 v248, v248, v156, v157
    v_and_b32 v248, 0xff, v248
    v_cmp_ne_u32 vcc, 0, v248
    s_nop 0
    s_cmp_eq_u64 vcc, 0
    s_cbranch_scc1 L_polld_14
    s_sub_u32 s71, s71, 1
    s_cmp_lg_u32 s71, 0
    s_cbranch_scc1 L_poll_13
L_polld_14:
    s_branch L_back_2
L_slow_3:
    s_nop 7
    s_mov_b32 s71, 20000
L_poll_15:
    buffer_load_dword v220, v219, s[36:39], s16 offen sc1
    s_waitcnt vmcnt(0)
    v_cmp_ne_u32 vcc, s15, v220
    s_nop 0
    s_cmp_eq_u64 vcc, 0
    s_cbranch_scc1 L_polld_16
    s_sub_u32 s71, s71, 1
    s_cmp_lg_u32 s71, 0
    s_cbranch_scc1 L_poll_15
L_polld_16:
    s_branch L_back_4
L_slow_5:
    s_nop 7
    s_mov_b32 s71, 20000
L_poll_17:
    buffer_load_dword v220, v219, s[36:39], s23 offen sc1
    s_waitcnt vmcnt(0)
    v_cmp_ne_u32 vcc, s15, v220
    s_nop 0
    s_cmp_eq_u64 vcc, 0
    s_cbranch_scc1 L_polld_18
    s_sub_u32 s71, s71, 1
    s_cmp_lg_u32 s71, 0
    s_cbranch_scc1 L_poll_17
L_polld_18:
    s_branch L_back_6
L_slow_7:
    s_nop 7
    s_mov_b32 s71, 20000
L_poll_19:
    buffer_load_dwordx4 v[176:179], v16, s[36:39], s12 offen offset:0 sc1
    buffer_load_dwordx4 v[180:183], v16, s[36:39], s12 offen offset:1024 sc1
    buffer_load_dwordx4 v[184:187], v16, s[36:39], s12 offen offset:2048 sc1
    buffer_load_dwordx4 v[188:191], v16, s[36:39], s12 offen offset:3072 sc1
    buffer_load_dwordx4 v[192:195], v16, s[36:39], s13 offen offset:0 sc1
    s_waitcnt vmcnt(0)
    v_xor_b32 v179, v30, v179
    v_xor_b32 v183, v30, v183
    v_xor_b32 v187, v30, v187
    v_xor_b32 v191, v30, v191
    v_xor_b32 v195, v30, v195
    v_or_b32 v248, v179, v183
    v_or3_b32 v248, v248, v187, v191
    v_or3_b32 v248, v248, v195, v195
    v_and_b32 v248, 0xff, v248
    v_cmp_ne_u32 vcc, 0, v248
    s_nop 0
    s_cmp_eq_u64 vcc, 0
    s_cbranch_scc1 L_polld_20
    s_sub_u32 s71, s71, 1
    s_cmp_lg_u32 s71, 0
    s_cbranch_scc1 L_poll_19
L_polld_20:
    v_lshlrev_b32 v144, 16, v176
    v_and_b32 v145, s14, v176
    v_lshlrev_b32 v146, 16, v177
    v_and_b32 v147, s14, v177
    v_lshlrev_b32 v148, 16, v178
    v_and_b32 v149, s14, v178
    v_mul_f32 v144, v144, v64
    v_mul_f32 v145, v145, v65
    v_mul_f32 v146, v146, v66
    v_mul_f32 v147, v147, v67
    v_mul_f32 v148, v148, v68
    v_mul_f32 v149, v149, v69
    v_mul_f32 v150, v179, v70
    v_lshlrev_b32 v151, 16, v180
    v_and_b32 v152, s14, v180
    v_lshlrev_b32 v153, 16, v181
    v_and_b32 v154, s14, v181
    v_lshlrev_b32 v155, 16, v182
    v_and_b32 v156, s14, v182
    v_mul_f32 v151, v151, v71
    v_mul_f32 v152, v152, v72
    v_mul_f32 v153, v153, v73
    v_mul_f32 v154, v154, v74
    v_mul_f32 v155, v155, v75
    v_mul_f32 v156, v156, v76
    v_mul_f32 v157, v183, v77
    v_lshlrev_b32 v158, 16, v184
    v_and_b32 v159, s14, v184
    v_lshlrev_b32 v160, 16, v185
    v_and_b32 v161, s14, v185
    v_lshlrev_b32 v162, 16, v186
    v_and_b32 v163, s14, v186
    v_mul_f32 v158, v158, v78
    v_mul_f32 v159, v159, v79
    v_mul_f32 v160, v160, v80
    v_mul_f32 v161, v161, v81
    v_mul_f32 v162, v162, v82
    v_mul_f32 v163, v163, v83
    v_mul_f32 v164, v187, v84
    v_lshlrev_b32 v165, 16, v188
    v_and_b32 v166, s14, v188
    v_lshlrev_b32 v167, 16, v189
    v_and_b32 v168, s14, v189
    v_lshlrev_b32 v169, 16, v190
    v_and_b32 v170, s14, v190
    v_mul_f32 v165, v165, v85
    v_mul_f32 v166, v166, v86
    v_mul_f32 v167, v167, v87
    v_mul_f32 v168, v168, v88
    v_mul_f32 v169, v169, v89
    v_mul_f32 v170, v170, v90
    v_mul_f32 v171, v191, v91
    v_mul_f32 v172, v192, v92
    v_mul_f32 v173, v193, v93
    v_mul_f32 v174, v194, v94
    v_mul_f32 v175, v195, v95
    s_nop 1
    s_branch L_back_8
L_slow_9:
    s_nop 7
    s_mov_b32 s71, 20000
L_poll_21:
    buffer_load_dword v227, v225, s[36:39], s22 offen sc1
    s_waitcnt vmcnt(0)
    v_cmp_ne_u32 vcc, s15, v227
    s_nop 0
    s_cmp_eq_u64 vcc, 0
    s_cbranch_scc1 L_polld_22
    s_sub_u32 s71, s71, 1
    s_cmp_lg_u32 s71, 0
    s_cbranch_scc1 L_poll_21
L_polld_22:
    s_branch L_back_10
L_slow_11:
    s_nop 7
    s_mov_b32 s71, 20000
L_poll_23:
    buffer_load_dword v18, v245, s[36:39], 0 offen sc1
    s_waitcnt vmcnt(0)
    v_cmp_ne_u32 vcc, s66, v18
    s_nop 0
    s_cmp_eq_u64 vcc, 0
    s_cbranch_scc1 L_polld_24
    s_sleep 2
    s_sub_u32 s71, s71, 1
    s_cmp_lg_u32 s71, 0
    s_cbranch_scc1 L_poll_23
L_polld_24:
    s_branch L_back_12
.p2align 12
L_helper:
    s_lshl_b32 s60, s68, 2
    s_add_u32 s60, s60, s67
    s_sub_u32 s60, s60, 28
    s_and_b32 s72, s60, 3
    s_lshl_b32 s73, s72, 2
    s_add_u32 s73, s73, s64
    s_and_b32 s61, s64, 1
    v_mov_b32 v2, 0
    v_lshlrev_b32 v4, 4, v1
    v_lshrrev_b32 v25, 4, v1
    v_and_b32 v24, 15, v1
    v_lshlrev_b32 v8, 9, v25
    v_lshl_add_u32 v8, v24, 3, v8
    v_subrev_u32 v9, 8, v8
    s_and_b32 s95, s60, 1
    s_lshl_b32 s95, s95, 1
    s_add_u32 s67, s64, 0
    s_add_u32 s67, s67, s95
    s_mul_i32 s68, s60, 14
    s_add_u32 s68, s68, s67
    s_and_b32 s69, s68, 31
    s_lshl_b32 s69, s69, 1
    s_bfe_u32 s70, s68, 0x10005
    s_add_u32 s69, s69, s70
    s_andn2_b32 s70, s68, 63
    s_add_u32 s69, s69, s70
    s_lshl_b32 s74, s69, 12
    s_lshl_b32 s82, s68, 12
    s_add_u32 s82, s82, 3145728
    s_waitcnt lgkmcnt(0)
    buffer_load_dword v3, v2, s[36:39], 0 offen sc1
    buffer_load_dwordx2 v[32:33], v9, s[52:55], s74 offen offset:0
    buffer_load_dwordx2 v[34:35], v8, s[52:55], s74 offen offset:0
    buffer_load_dwordx2 v[36:37], v8, s[52:55], s74 offen offset:2040
    buffer_load_dwordx2 v[38:39], v8, s[52:55], s74 offen offset:2048
    buffer_load_dwordx2 v[40:41], v8, s[52:55], s74 offen offset:120
    buffer_load_dwordx2 v[42:43], v8, s[52:55], s74 offen offset:128
    buffer_load_dwordx2 v[44:45], v8, s[52:55], s74 offen offset:2168
    buffer_load_dwordx2 v[46:47], v8, s[52:55], s74 offen offset:2176
    buffer_load_dwordx2 v[48:49], v8, s[52:55], s74 offen offset:248
    buffer_load_dwordx2 v[50:51], v8, s[52:55], s74 offen offset:256
    buffer_load_dwordx2 v[52:53], v8, s[52:55], s74 offen offset:2296
    buffer_load_dwordx2 v[54:55], v8, s[52:55], s74 offen offset:2304
    buffer_load_dwordx2 v[56:57], v8, s[52:55], s74 offen offset:376
    buffer_load_dwordx2 v[58:59], v8, s[52:55], s74 offen offset:384
    buffer_load_dwordx2 v[60:61], v8, s[52:55], s74 offen offset:2424
    buffer_load_dwordx2 v[62:63], v8, s[52:55], s74 offen offset:2432
    s_mul_i32 s69, s73, 100352
    s_bfe_u32 s70, s60, 0x10002
    s_mul_i32 s70, s70, 896
    s_add_u32 s69, s69, s70
    v_lshrrev_b32 v64, 3, v1
    v_min_u32 v64, 6, v64
    v_and_b32 v65, 7, v1
    v_min_u32 v65, 6, v65
    v_mul_u32_u24 v64, 3584, v64
    v_lshl_add_u32 v64, v65, 7, v64
    buffer_load_dword v6, v64, s[24:27], s69 offen
    s_add_u32 s69, s69, 25088
    buffer_load_dword v6, v64, s[24:27], s69 offen
    s_add_u32 s69, s69, 25088
    buffer_load_dword v6, v64, s[24:27], s69 offen
    s_add_u32 s69, s69, 25088
    buffer_load_dword v6, v64, s[24:27], s69 offen
    s_lshr_b32 s67, s60, 3
    s_lshl_b32 s67, s67, 2
    s_add_u32 s3, s67, s72
    s_add_u32 s67, s64, 4
    s_add_u32 s67, s67, s95
    s_mul_i32 s68, s60, 14
    s_add_u32 s68, s68, s67
    s_and_b32 s69, s68, 31
    s_lshl_b32 s69, s69, 1
    s_bfe_u32 s70, s68, 0x10005
    s_add_u32 s69, s69, s70
    s_andn2_b32 s70, s68, 63
    s_add_u32 s69, s69, s70
    s_lshl_b32 s75, s69, 12
    s_lshl_b32 s83, s68, 12
    s_add_u32 s83, s83, 3145728
    s_add_u32 s67, s64, 8
    s_add_u32 s67, s67, s95
    s_mul_i32 s68, s60, 14
    s_add_u32 s68, s68, s67
    s_and_b32 s69, s68, 31
    s_lshl_b32 s69, s69, 1
    s_bfe_u32 s70, s68, 0x10005
    s_add_u32 s69, s69, s70
    s_andn2_b32 s70, s68, 63
    s_add_u32 s69, s69, s70
    s_lshl_b32 s76, s69, 12
    s_lshl_b32 s84, s68, 12
    s_add_u32 s84, s84, 3145728
    s_lshr_b32 s67, s64, 1
    s_add_u32 s99, s67, s95
    s_xor_b32 s99, s99, s64
    s_lshl_b32 s99, s99, 4
    s_mul_i32 s68, s95, 6
    s_sub_u32 s67, s67, s68
    s_add_u32 s67, s67, 12
    s_mul_i32 s68, s60, 14
    s_add_u32 s68, s68, s67
    s_and_b32 s69, s68, 31
    s_lshl_b32 s69, s69, 1
    s_bfe_u32 s70, s68, 0x10005
    s_add_u32 s69, s69, s70
    s_andn2_b32 s70, s68, 63
    s_add_u32 s69, s69, s70
    s_lshl_b32 s77, s69, 12
    s_lshl_b32 s85, s68, 12
    s_add_u32 s85, s85, 3145728
    s_mov_b32 s79, 18432
    s_mov_b32 s80, 18432
    s_lshl_b32 s69, s61, 10
    s_sub_u32 s81, 4294930432, s69
    s_mov_b32 s97, 0
    s_mov_b32 s98, 0
    s_lshl_b32 s69, s61, 11
    s_add_u32 s85, s85, s69
    s_mov_b32 s87, 0
    s_mov_b32 s88, 0
    s_lshl_b32 s89, s61, 8
    s_mul_i32 s62, s60, 128
    s_add_u32 s62, s62, 32768
    s_cmp_eq_u32 s64, 0
    s_cselect_b32 s62, s62, 20971520
    v_lshlrev_b32 v26, 3, v25
    v_sub_u32 v26, v24, v26
    v_add_u32 v26, 25, v26
    v_sub_u32 v5, 0, v26
    v_and_b32 v5, 3, v5
    v_mul_u32_u24 v5, 4162, v5
    v_lshl_add_u32 v5, v26, 1, v5
    s_mul_i32 s69, s64, 16640
    s_add_u32 s69, s69, 56320
    v_add_u32 v5, s69, v5
    s_add_u32 s69, s69, 32
    v_add_u32 v13, s69, v8
    v_lshl_add_u32 v26, v24, 1, v25
    v_add_u32 v26, 2, v26
    v_lshrrev_b32 v14, 2, v26
    v_add_u32 v14, 3, v14
    v_xor_b32 v14, s64, v14
    v_and_b32 v14, 3, v14
    v_lshlrev_b32 v14, 4, v14
    v_lshl_add_u32 v14, v26, 6, v14
    v_add_u32 v14, 1024, v14
    v_lshrrev_b32 v15, 2, v26
    v_add_u32 v15, 2, v15
    v_xor_b32 v15, s64, v15
    v_and_b32 v15, 3, v15
    v_lshlrev_b32 v15, 4, v15
    v_lshl_add_u32 v15, v26, 6, v15
    v_add_u32 v15, 1024, v15
    v_lshrrev_b32 v16, 2, v26
    v_add_u32 v16, 1, v16
    v_xor_b32 v16, s64, v16
    v_and_b32 v16, 3, v16
    v_lshlrev_b32 v16, 4, v16
    v_lshl_add_u32 v16, v26, 6, v16
    v_add_u32 v16, 1024, v16
    v_lshrrev_b32 v17, 2, v26
    v_add_u32 v17, 0, v17
    v_xor_b32 v17, s64, v17
    v_and_b32 v17, 3, v17
    v_lshlrev_b32 v17, 4, v17
    v_lshl_add_u32 v17, v26, 6, v17
    v_add_u32 v17, 1024, v17
    v_lshlrev_b32 v12, 5, v24
    v_bfe_u32 v26, v1, 4, 1
    v_lshl_add_u32 v12, v26, 9, v12
    v_lshrrev_b32 v26, 5, v1
    v_lshl_add_u32 v12, v26, 4, v12
    v_xor_b32 v24, v25, v1
    v_and_b32 v24, 3, v24
    v_lshrrev_b32 v26, 2, v1
    v_mul_u32_u24 v26, 7168, v26
    v_lshl_add_u32 v18, v24, 4, v26
    v_add_u32 v19, 113664, v18
    v_add_u32 v20, 227328, v18
    v_add_u32 v21, 340992, v18
    v_mov_b32 v96, 0
    v_mov_b32 v97, 0
    v_mov_b32 v98, 0
    v_mov_b32 v99, 0
    v_bfe_u32 v24, v1, 1, 4
    v_and_b32 v26, 1, v1
    v_mul_u32_u24 v24, 4160, v24
    v_lshl_add_u32 v24, v26, 4, v24
    v_add_u32 v24, 56320, v24
    ds_write_b128 v24, v[96:99]
    v_and_b32 v24, 127, v0
    v_lshlrev_b32 v24, 4, v24
    ds_write_b128 v24, v[96:99] offset:1024
    ds_write_b128 v24, v[96:99] offset:19456
    ds_write_b128 v24, v[96:99] offset:37888
    s_waitcnt vmcnt(20)
    v_readfirstlane_b32 s66, v3
    s_nop 0
    s_mul_i32 s66, s66, 0x9E3779B1
    s_add_u32 s66, s66, 0x7F4A7C15
    v_mov_b32 v3, s66
    s_waitcnt vmcnt(18)
    v_alignbit_b32 v112, v34, v33, 16
    v_alignbit_b32 v113, v35, v34, 16
    v_mov_b32 v114, v33
    v_mov_b32 v115, v34
    v_alignbit_b32 v116, v33, v32, 16
    v_mov_b32 v117, v112
    ds_write_b64 v13, v[34:35] offset:0
    ds_write_b64 v13, v[112:113] offset:4160
    ds_write_b64 v13, v[114:115] offset:8320
    ds_write_b64 v13, v[116:117] offset:12480
    s_waitcnt vmcnt(16)
    v_alignbit_b32 v118, v38, v37, 16
    v_alignbit_b32 v119, v39, v38, 16
    v_mov_b32 v120, v37
    v_mov_b32 v121, v38
    v_alignbit_b32 v122, v37, v36, 16
    v_mov_b32 v123, v118
    ds_write_b64 v13, v[38:39] offset:2048
    ds_write_b64 v13, v[118:119] offset:6208
    ds_write_b64 v13, v[120:121] offset:10368
    ds_write_b64 v13, v[122:123] offset:14528
    s_waitcnt vmcnt(14)
    v_alignbit_b32 v24, v42, v41, 16
    v_alignbit_b32 v25, v43, v42, 16
    v_mov_b32 v26, v41
    v_mov_b32 v27, v42
    v_alignbit_b32 v28, v41, v40, 16
    v_mov_b32 v29, v24
    ds_write_b64 v13, v[42:43] offset:128
    ds_write_b64 v13, v[24:25] offset:4288
    ds_write_b64 v13, v[26:27] offset:8448
    ds_write_b64 v13, v[28:29] offset:12608
    s_waitcnt vmcnt(12)
    v_alignbit_b32 v104, v46, v45, 16
    v_alignbit_b32 v105, v47, v46, 16
    v_mov_b32 v106, v45
    v_mov_b32 v107, v46
    v_alignbit_b32 v108, v45, v44, 16
    v_mov_b32 v109, v104
    ds_write_b64 v13, v[46:47] offset:2176
    ds_write_b64 v13, v[104:105] offset:6336
    ds_write_b64 v13, v[106:107] offset:10496
    ds_write_b64 v13, v[108:109] offset:14656
    s_waitcnt lgkmcnt(0)
    s_waitcnt vmcnt(10)
    v_alignbit_b32 v112, v50, v49, 16
    v_alignbit_b32 v113, v51, v50, 16
    v_mov_b32 v114, v49
    v_mov_b32 v115, v50
    v_alignbit_b32 v116, v49, v48, 16
    v_mov_b32 v117, v112
    ds_write_b64 v13, v[50:51] offset:256
    ds_write_b64 v13, v[112:113] offset:4416
    ds_write_b64 v13, v[114:115] offset:8576
    ds_write_b64 v13, v[116:117] offset:12736
    s_waitcnt vmcnt(8)
    v_alignbit_b32 v118, v54, v53, 16
    v_alignbit_b32 v119, v55, v54, 16
    v_mov_b32 v120, v53
    v_mov_b32 v121, v54
    v_alignbit_b32 v122, v53, v52, 16
    v_mov_b32 v123, v118
    ds_write_b64 v13, v[54:55] offset:2304
    ds_write_b64 v13, v[118:119] offset:6464
    ds_write_b64 v13, v[120:121] offset:10624
    ds_write_b64 v13, v[122:123] offset:14784
    s_waitcnt vmcnt(6)
    v_alignbit_b32 v24, v58, v57, 16
    v_alignbit_b32 v25, v59, v58, 16
    v_mov_b32 v26, v57
    v_mov_b32 v27, v58
    v_alignbit_b32 v28, v57, v56, 16
    v_mov_b32 v29, v24
    ds_write_b64 v13, v[58:59] offset:384
    ds_write_b64 v13, v[24:25] offset:4544
    ds_write_b64 v13, v[26:27] offset:8704
    ds_write_b64 v13, v[28:29] offset:12864
    s_waitcnt vmcnt(4)
    v_alignbit_b32 v104, v62, v61, 16
    v_alignbit_b32 v105, v63, v62, 16
    v_mov_b32 v106, v61
    v_mov_b32 v107, v62
    v_alignbit_b32 v108, v61, v60, 16
    v_mov_b32 v109, v104
    ds_write_b64 v13, v[62:63] offset:2432
    ds_write_b64 v13, v[104:105] offset:6592
    ds_write_b64 v13, v[106:107] offset:10752
    ds_write_b64 v13, v[108:109] offset:14912
    s_waitcnt lgkmcnt(0)
    s_lshl_b32 s69, s60, 2
    s_add_u32 s69, s69, s64
    s_mul_i32 s94, s69, 6272
    v_min_u32 v7, 48, v1
    v_lshlrev_b32 v7, 7, v7
    s_lshl_b32 s69, s64, 12
    s_add_u32 s69, s69, 122880
    v_add_u32 v10, s69, v4
    s_xor_b32 s69, s64, 1
    s_lshl_b32 s69, s69, 12
    s_add_u32 s69, s69, 122880
    v_add_u32 v11, s69, v4
    s_mul_i32 s69, s60, 14
    s_lshr_b32 s70, s69, 6
    s_min_u32 s70, s70, 5
    s_mul_i32 s70, s70, 4096
    s_add_u32 s70, s70, 4096
    v_mul_u32_u24 v25, 128, v1
    s_add_u32 s69, s69, s95
    s_lshl_b32 s69, s69, 4
    s_mul_i32 s68, s64, 458752
    s_add_u32 s69, s69, s68
    s_add_u32 s92, s69, 1048576
    s_lshl_b32 s91, s64, 12
    s_add_u32 s91, s91, 3072
    s_mov_b32 s72, s91
    s_lshl_b32 s93, s95, 7
    s_sub_u32 s93, 64, s93
    s_mov_b32 s63, 0
    s_mov_b32 s90, 20971520
    s_mov_b64 exec, 0
    s_cmp_eq_u32 s64, 0
    s_cbranch_scc1 L_pad101
    s_cmp_eq_u32 s64, 1
    s_cbranch_scc1 L_pad102
L_hop3:
    s_mov_b64 exec, -1
    s_cmp_lg_u32 s64, 0
    s_cbranch_scc1 L_polld_26
    s_mov_b32 s71, 20000
L_poll_25:
    buffer_load_dword v26, v25, s[36:39], s70 offen sc1
    s_waitcnt vmcnt(0)
    v_cmp_ne_u32 vcc, s66, v26
    s_nop 0
    s_cmp_eq_u64 vcc, 0
    s_cbranch_scc1 L_polld_26
    s_sub_u32 s71, s71, 1
    s_cmp_lg_u32 s71, 0
    s_cbranch_scc1 L_poll_25
L_polld_26:
    s_barrier
    s_mov_b32 m0, s91
    s_nop 0
    buffer_load_dwordx4 v18, s[36:39], s92 offen offset:0 sc1 lds
    buffer_load_dwordx4 v19, s[36:39], s92 offen offset:1024 sc1 lds
    buffer_load_dwordx4 v20, s[36:39], s92 offen offset:2048 sc1 lds
    buffer_load_dwordx4 v21, s[36:39], s92 offen offset:3072 sc1 lds
    s_add_u32 s91, s91, 18432
    s_add_u32 s92, s92, 64
    s_sub_u32 vcc_lo, 0, s61
    s_mov_b32 vcc_hi, vcc_lo
    buffer_load_dwordx2 v[32:33], v9, s[52:55], s75 offen offset:0
    buffer_load_dwordx2 v[34:35], v8, s[52:55], s75 offen offset:0
    buffer_load_dwordx2 v[36:37], v8, s[52:55], s75 offen offset:2040
    buffer_load_dwordx2 v[38:39], v8, s[52:55], s75 offen offset:2048
    buffer_load_dwordx2 v[40:41], v8, s[52:55], s75 offen offset:120
    buffer_load_dwordx2 v[42:43], v8, s[52:55], s75 offen offset:128
    buffer_load_dwordx2 v[44:45], v8, s[52:55], s75 offen offset:2168
    buffer_load_dwordx2 v[46:47], v8, s[52:55], s75 offen offset:2176
    s_waitcnt vmcnt(8)
    s_waitcnt lgkmcnt(0)
    s_barrier
    ds_read_b64 v[192:193], v5 offset:0
    ds_read_b64 v[194:195], v5 offset:8
    ds_read_b128 v[128:131], v14 offset:1792
    ds_read_b64 v[196:197], v5 offset:512
    ds_read_b64 v[198:199], v5 offset:520
    ds_read_b128 v[132:135], v14 offset:3840
    ds_read_b64 v[200:201], v5 offset:1024
    ds_read_b64 v[202:203], v5 offset:1032
    ds_read_b128 v[136:139], v14 offset:5888
    ds_read_b64 v[204:205], v5 offset:1536
    ds_read_b64 v[206:207], v5 offset:1544
    ds_read_b128 v[140:143], v14 offset:7936
    ds_read_b64 v[208:209], v5 offset:2048
    ds_read_b64 v[210:211], v5 offset:2056
    ds_read_b128 v[144:147], v14 offset:9984
    ds_read_b64 v[212:213], v5 offset:2560
    ds_read_b64 v[214:215], v5 offset:2568
    ds_read_b128 v[148:151], v14 offset:12032
    ds_read_b64 v[216:217], v5 offset:3072
    ds_read_b64 v[218:219], v5 offset:3080
    ds_read_b128 v[152:155], v14 offset:14080
    ds_read_b64 v[220:221], v5 offset:3584
    ds_read_b64 v[222:223], v5 offset:3592
    ds_read_b128 v[156:159], v14 offset:16128
    s_waitcnt lgkmcnt(0)
L_conv:
    s_waitcnt lgkmcnt(6)
    v_mfma_f32_16x16x32_bf16 v[64:67], v[192:195], v[128:131], 0
    ds_read_b64 v[224:225], v5 offset:64
    v_mfma_f32_16x16x32_bf16 v[68:71], v[192:195], v[132:135], 0
    ds_read_b64 v[226:227], v5 offset:72
    v_mfma_f32_16x16x32_bf16 v[68:71], v[196:199], v[128:131], v[68:71]
    buffer_load_dwordx2 v[48:49], v8, s[52:55], s75 offen offset:248
    v_mfma_f32_16x16x32_bf16 v[72:75], v[192:195], v[136:139], 0
    ds_read_b128 v[160:163], v15 offset:1536
    v_cvt_pk_bf16_f32 v104, v80, v81
    v_mfma_f32_16x16x32_bf16 v[72:75], v[196:199], v[132:135], v[72:75]
    ds_read_b64 v[228:229], v5 offset:576
    v_cvt_pk_bf16_f32 v105, v82, v83
    v_mfma_f32_16x16x32_bf16 v[72:75], v[200:203], v[128:131], v[72:75]
    ds_read_b64 v[230:231], v5 offset:584
    v_cvt_pk_bf16_f32 v106, v84, v85
    v_mfma_f32_16x16x32_bf16 v[76:79], v[192:195], v[140:143], 0
    ds_read_b128 v[164:167], v15 offset:3584
    v_cvt_pk_bf16_f32 v107, v86, v87
    v_mfma_f32_16x16x32_bf16 v[76:79], v[196:199], v[136:139], v[76:79]
    buffer_load_dwordx2 v[50:51], v8, s[52:55], s75 offen offset:256
    v_mfma_f32_16x16x32_bf16 v[76:79], v[200:203], v[132:135], v[76:79]
    ds_read_b64 v[232:233], v5 offset:1088
    v_permlane16_swap_b32 v96, v98
    v_mfma_f32_16x16x32_bf16 v[76:79], v[204:207], v[128:131], v[76:79]
    ds_read_b64 v[234:235], v5 offset:1096
    v_permlane16_swap_b32 v97, v99
    v_mfma_f32_16x16x32_bf16 v[80:83], v[192:195], v[144:147], 0
    ds_read_b128 v[168:171], v15 offset:5632
    v_permlane16_swap_b32 v100, v102
    v_mfma_f32_16x16x32_bf16 v[80:83], v[196:199], v[140:143], v[80:83]
    ds_read_b64 v[236:237], v5 offset:1600
    v_permlane16_swap_b32 v101, v103
    v_mfma_f32_16x16x32_bf16 v[80:83], v[200:203], v[136:139], v[80:83]
    buffer_load_dwordx2 v[52:53], v8, s[52:55], s75 offen offset:2296
    v_mfma_f32_16x16x32_bf16 v[80:83], v[204:207], v[132:135], v[80:83]
    ds_read_b64 v[238:239], v5 offset:1608
    v_cvt_pk_bf16_f32 v108, v88, v89
    v_mfma_f32_16x16x32_bf16 v[80:83], v[208:211], v[128:131], v[80:83]
    ds_read_b128 v[172:175], v15 offset:7680
    v_cvt_pk_bf16_f32 v109, v90, v91
    s_waitcnt lgkmcnt(12)
    v_mfma_f32_16x16x32_bf16 v[84:87], v[192:195], v[148:151], 0
    ds_read_b64 v[240:241], v5 offset:2112
    v_cvt_pk_bf16_f32 v110, v92, v93
    v_mfma_f32_16x16x32_bf16 v[84:87], v[196:199], v[144:147], v[84:87]
    ds_read_b64 v[242:243], v5 offset:2120
    v_cvt_pk_bf16_f32 v111, v94, v95
    v_mfma_f32_16x16x32_bf16 v[84:87], v[200:203], v[140:143], v[84:87]
    buffer_load_dwordx2 v[54:55], v8, s[52:55], s75 offen offset:2304
    v_mfma_f32_16x16x32_bf16 v[84:87], v[204:207], v[136:139], v[84:87]
    ds_read_b128 v[176:179], v15 offset:9728
    v_permlane16_swap_b32 v104, v106
    v_mfma_f32_16x16x32_bf16 v[84:87], v[208:211], v[132:135], v[84:87]
    ds_read_b64 v[244:245], v5 offset:2624
    v_permlane16_swap_b32 v105, v107
    v_mfma_f32_16x16x32_bf16 v[84:87], v[212:215], v[128:131], v[84:87]
    ds_read_b64 v[246:247], v5 offset:2632
    v_permlane16_swap_b32 v108, v110
    v_mfma_f32_16x16x32_bf16 v[88:91], v[192:195], v[152:155], 0
    ds_read_b128 v[180:183], v15 offset:11776
    v_permlane16_swap_b32 v109, v111
    v_mfma_f32_16x16x32_bf16 v[88:91], v[196:199], v[148:151], v[88:91]
    v_mfma_f32_16x16x32_bf16 v[88:91], v[200:203], v[144:147], v[88:91]
    ds_read_b64 v[248:249], v5 offset:3136
    v_mfma_f32_16x16x32_bf16 v[88:91], v[204:207], v[140:143], v[88:91]
    ds_read_b64 v[250:251], v5 offset:3144
    v_mfma_f32_16x16x32_bf16 v[88:91], v[208:211], v[136:139], v[88:91]
    ds_read_b128 v[184:187], v15 offset:13824
    v_mfma_f32_16x16x32_bf16 v[88:91], v[212:215], v[132:135], v[88:91]
    ds_read_b64 v[252:253], v5 offset:3648
    v_mfma_f32_16x16x32_bf16 v[88:91], v[216:219], v[128:131], v[88:91]
    buffer_store_dwordx4 v[96:99], v12, s[36:39], s90 offen offset:0 sc1
    v_mfma_f32_16x16x32_bf16 v[92:95], v[192:195], v[156:159], 0
    ds_read_b64 v[254:255], v5 offset:3656
    v_mfma_f32_16x16x32_bf16 v[92:95], v[196:199], v[152:155], v[92:95]
    ds_read_b128 v[188:191], v15 offset:15872
    v_mfma_f32_16x16x32_bf16 v[92:95], v[200:203], v[148:151], v[92:95]
    v_mfma_f32_16x16x32_bf16 v[92:95], v[204:207], v[144:147], v[92:95]
    v_mfma_f32_16x16x32_bf16 v[92:95], v[208:211], v[140:143], v[92:95]
    buffer_store_dwordx4 v[100:103], v12, s[36:39], s90 offen offset:1024 sc1
    v_mfma_f32_16x16x32_bf16 v[92:95], v[212:215], v[136:139], v[92:95]
    v_mfma_f32_16x16x32_bf16 v[92:95], v[216:219], v[132:135], v[92:95]
    v_mfma_f32_16x16x32_bf16 v[92:95], v[220:223], v[128:131], v[92:95]
    s_waitcnt lgkmcnt(9)
    v_mfma_f32_16x16x32_bf16 v[64:67], v[224:227], v[160:163], v[64:67]
    ds_read_b64 v[192:193], v5 offset:128
    v_mfma_f32_16x16x32_bf16 v[68:71], v[224:227], v[164:167], v[68:71]
    ds_read_b64 v[194:195], v5 offset:136
    v_mfma_f32_16x16x32_bf16 v[68:71], v[228:231], v[160:163], v[68:71]
    buffer_store_dwordx4 v[104:107], v12, s[36:39], s90 offen offset:2048 sc1
    v_mfma_f32_16x16x32_bf16 v[72:75], v[224:227], v[168:171], v[72:75]
    ds_read_b128 v[128:131], v16 offset:1280
    v_mfma_f32_16x16x32_bf16 v[72:75], v[228:231], v[164:167], v[72:75]
    ds_read_b64 v[196:197], v5 offset:640
    v_mfma_f32_16x16x32_bf16 v[72:75], v[232:235], v[160:163], v[72:75]
    ds_read_b64 v[198:199], v5 offset:648
    v_mfma_f32_16x16x32_bf16 v[76:79], v[224:227], v[172:175], v[76:79]
    ds_read_b128 v[132:135], v16 offset:3328
    v_mfma_f32_16x16x32_bf16 v[76:79], v[228:231], v[168:171], v[76:79]
    buffer_store_dwordx4 v[108:111], v12, s[36:39], s90 offen offset:3072 sc1
    v_mfma_f32_16x16x32_bf16 v[76:79], v[232:235], v[164:167], v[76:79]
    ds_read_b64 v[200:201], v5 offset:1152
    v_mfma_f32_16x16x32_bf16 v[76:79], v[236:239], v[160:163], v[76:79]
    ds_read_b64 v[202:203], v5 offset:1160
    v_mfma_f32_16x16x32_bf16 v[80:83], v[224:227], v[176:179], v[80:83]
    ds_read_b128 v[136:139], v16 offset:5376
    v_mfma_f32_16x16x32_bf16 v[80:83], v[228:231], v[172:175], v[80:83]
    ds_read_b64 v[204:205], v5 offset:1664
    v_mfma_f32_16x16x32_bf16 v[80:83], v[232:235], v[168:171], v[80:83]
    buffer_load_dwordx2 v[56:57], v8, s[52:55], s75 offen offset:376
    v_mfma_f32_16x16x32_bf16 v[80:83], v[236:239], v[164:167], v[80:83]
    ds_read_b64 v[206:207], v5 offset:1672
    v_mfma_f32_16x16x32_bf16 v[80:83], v[240:243], v[160:163], v[80:83]
    ds_read_b128 v[140:143], v16 offset:7424
    s_waitcnt lgkmcnt(12)
    v_mfma_f32_16x16x32_bf16 v[84:87], v[224:227], v[180:183], v[84:87]
    ds_read_b64 v[208:209], v5 offset:2176
    v_mfma_f32_16x16x32_bf16 v[84:87], v[228:231], v[176:179], v[84:87]
    ds_read_b64 v[210:211], v5 offset:2184
    v_mfma_f32_16x16x32_bf16 v[84:87], v[232:235], v[172:175], v[84:87]
    buffer_load_dwordx2 v[58:59], v8, s[52:55], s75 offen offset:384
    v_mfma_f32_16x16x32_bf16 v[84:87], v[236:239], v[168:171], v[84:87]
    ds_read_b128 v[144:147], v16 offset:9472
    v_mfma_f32_16x16x32_bf16 v[84:87], v[240:243], v[164:167], v[84:87]
    ds_read_b64 v[212:213], v5 offset:2688
    v_mfma_f32_16x16x32_bf16 v[84:87], v[244:247], v[160:163], v[84:87]
    ds_read_b64 v[214:215], v5 offset:2696
    s_waitcnt vmcnt(16)
    v_mfma_f32_16x16x32_bf16 v[88:91], v[224:227], v[184:187], v[88:91]
    ds_read_b128 v[148:151], v16 offset:11520
    v_alignbit_b32 v112, v34, v33, 16
    v_mfma_f32_16x16x32_bf16 v[88:91], v[228:231], v[180:183], v[88:91]
    buffer_load_dwordx2 v[60:61], v8, s[52:55], s75 offen offset:2424
    v_mfma_f32_16x16x32_bf16 v[88:91], v[232:235], v[176:179], v[88:91]
    ds_read_b64 v[216:217], v5 offset:3200
    v_alignbit_b32 v113, v35, v34, 16
    v_mfma_f32_16x16x32_bf16 v[88:91], v[236:239], v[172:175], v[88:91]
    ds_read_b64 v[218:219], v5 offset:3208
    v_mov_b32 v114, v33
    v_mfma_f32_16x16x32_bf16 v[88:91], v[240:243], v[168:171], v[88:91]
    ds_read_b128 v[152:155], v16 offset:13568
    v_mov_b32 v115, v34
    v_mfma_f32_16x16x32_bf16 v[88:91], v[244:247], v[164:167], v[88:91]
    ds_read_b64 v[220:221], v5 offset:3712
    v_alignbit_b32 v116, v33, v32, 16
    v_mfma_f32_16x16x32_bf16 v[88:91], v[248:251], v[160:163], v[88:91]
    buffer_load_dwordx2 v[62:63], v8, s[52:55], s75 offen offset:2432
    v_mfma_f32_16x16x32_bf16 v[92:95], v[224:227], v[188:191], v[92:95]
    ds_read_b64 v[222:223], v5 offset:3720
    v_mov_b32 v117, v112
    v_mfma_f32_16x16x32_bf16 v[92:95], v[228:231], v[184:187], v[92:95]
    ds_read_b128 v[156:159], v16 offset:15616
    v_mfma_f32_16x16x32_bf16 v[92:95], v[232:235], v[180:183], v[92:95]
    v_mfma_f32_16x16x32_bf16 v[92:95], v[236:239], v[176:179], v[92:95]
    v_mfma_f32_16x16x32_bf16 v[92:95], v[240:243], v[172:175], v[92:95]
    v_mfma_f32_16x16x32_bf16 v[92:95], v[244:247], v[168:171], v[92:95]
    v_mfma_f32_16x16x32_bf16 v[92:95], v[248:251], v[164:167], v[92:95]
    v_mfma_f32_16x16x32_bf16 v[92:95], v[252:255], v[160:163], v[92:95]
    s_waitcnt lgkmcnt(9)
    v_mfma_f32_16x16x32_bf16 v[64:67], v[192:195], v[128:131], v[64:67]
    ds_read_b64 v[224:225], v5 offset:192
    v_mfma_f32_16x16x32_bf16 v[68:71], v[192:195], v[132:135], v[68:71]
    ds_read_b64 v[226:227], v5 offset:200
    v_mfma_f32_16x16x32_bf16 v[68:71], v[196:199], v[128:131], v[68:71]
    ds_write_b64 v13, v[34:35] offset:0
    v_mfma_f32_16x16x32_bf16 v[72:75], v[192:195], v[136:139], v[72:75]
    ds_read_b128 v[160:163], v17 offset:1024
    v_mfma_f32_16x16x32_bf16 v[72:75], v[196:199], v[132:135], v[72:75]
    ds_read_b64 v[228:229], v5 offset:704
    v_mfma_f32_16x16x32_bf16 v[72:75], v[200:203], v[128:131], v[72:75]
    ds_read_b64 v[230:231], v5 offset:712
    v_mfma_f32_16x16x32_bf16 v[76:79], v[192:195], v[140:143], v[76:79]
    ds_write_b64 v13, v[112:113] offset:4160
    v_mfma_f32_16x16x32_bf16 v[76:79], v[196:199], v[136:139], v[76:79]
    ds_read_b128 v[164:167], v17 offset:3072
    v_mfma_f32_16x16x32_bf16 v[76:79], v[200:203], v[132:135], v[76:79]
    ds_read_b64 v[232:233], v5 offset:1216
    v_mfma_f32_16x16x32_bf16 v[76:79], v[204:207], v[128:131], v[76:79]
    ds_read_b64 v[234:235], v5 offset:1224
    v_mfma_f32_16x16x32_bf16 v[80:83], v[192:195], v[144:147], v[80:83]
    ds_write_b64 v13, v[114:115] offset:8320
    v_mfma_f32_16x16x32_bf16 v[80:83], v[196:199], v[140:143], v[80:83]
    ds_read_b128 v[168:171], v17 offset:5120
    v_mfma_f32_16x16x32_bf16 v[80:83], v[200:203], v[136:139], v[80:83]
    ds_read_b64 v[236:237], v5 offset:1728
    v_mfma_f32_16x16x32_bf16 v[80:83], v[204:207], v[132:135], v[80:83]
    ds_read_b64 v[238:239], v5 offset:1736
    v_mfma_f32_16x16x32_bf16 v[80:83], v[208:211], v[128:131], v[80:83]
    ds_write_b64 v13, v[116:117] offset:12480
    s_waitcnt lgkmcnt(15)
    v_mfma_f32_16x16x32_bf16 v[84:87], v[192:195], v[148:151], v[84:87]
    ds_read_b128 v[172:175], v17 offset:7168
    v_mfma_f32_16x16x32_bf16 v[84:87], v[196:199], v[144:147], v[84:87]
    ds_read_b64 v[240:241], v5 offset:2240
    v_mfma_f32_16x16x32_bf16 v[84:87], v[200:203], v[140:143], v[84:87]
    ds_read_b64 v[242:243], v5 offset:2248
    v_mfma_f32_16x16x32_bf16 v[84:87], v[204:207], v[136:139], v[84:87]
    s_mov_b32 m0, s91
    v_mfma_f32_16x16x32_bf16 v[84:87], v[208:211], v[132:135], v[84:87]
    ds_read_b128 v[176:179], v17 offset:9216
    v_mfma_f32_16x16x32_bf16 v[84:87], v[212:215], v[128:131], v[84:87]
    ds_read_b64 v[244:245], v5 offset:2752
    s_waitcnt vmcnt(16)
    v_mfma_f32_16x16x32_bf16 v[88:91], v[192:195], v[152:155], v[88:91]
    ds_read_b64 v[246:247], v5 offset:2760
    v_alignbit_b32 v118, v38, v37, 16
    v_mfma_f32_16x16x32_bf16 v[88:91], v[196:199], v[148:151], v[88:91]
    buffer_load_dwordx4 v18, s[36:39], s92 offen offset:0 sc1 lds
    v_mfma_f32_16x16x32_bf16 v[88:91], v[200:203], v[144:147], v[88:91]
    ds_read_b128 v[180:183], v17 offset:11264
    v_alignbit_b32 v119, v39, v38, 16
    v_mfma_f32_16x16x32_bf16 v[88:91], v[204:207], v[140:143], v[88:91]
    ds_read_b64 v[248:249], v5 offset:3264
    v_mov_b32 v120, v37
    v_mfma_f32_16x16x32_bf16 v[88:91], v[208:211], v[136:139], v[88:91]
    ds_read_b64 v[250:251], v5 offset:3272
    v_mov_b32 v121, v38
    v_mfma_f32_16x16x32_bf16 v[88:91], v[212:215], v[132:135], v[88:91]
    buffer_load_dwordx4 v19, s[36:39], s92 offen offset:1024 sc1 lds
    v_mfma_f32_16x16x32_bf16 v[88:91], v[216:219], v[128:131], v[88:91]
    ds_read_b128 v[184:187], v17 offset:13312
    v_alignbit_b32 v122, v37, v36, 16
    v_mfma_f32_16x16x32_bf16 v[92:95], v[192:195], v[156:159], v[92:95]
    ds_read_b64 v[252:253], v5 offset:3776
    v_mov_b32 v123, v118
    v_mfma_f32_16x16x32_bf16 v[92:95], v[196:199], v[152:155], v[92:95]
    ds_read_b64 v[254:255], v5 offset:3784
    v_mfma_f32_16x16x32_bf16 v[92:95], v[200:203], v[148:151], v[92:95]
    ds_read_b128 v[188:191], v17 offset:15360
    v_mfma_f32_16x16x32_bf16 v[92:95], v[204:207], v[144:147], v[92:95]
    v_mfma_f32_16x16x32_bf16 v[92:95], v[208:211], v[140:143], v[92:95]
    v_mfma_f32_16x16x32_bf16 v[92:95], v[212:215], v[136:139], v[92:95]
    v_mfma_f32_16x16x32_bf16 v[92:95], v[216:219], v[132:135], v[92:95]
    v_mfma_f32_16x16x32_bf16 v[92:95], v[220:223], v[128:131], v[92:95]
    s_waitcnt lgkmcnt(9)
    v_mfma_f32_16x16x32_bf16 v[64:67], v[224:227], v[160:163], v[64:67]
    ds_read_b64 v[192:193], v5 offset:256
    v_mfma_f32_16x16x32_bf16 v[68:71], v[224:227], v[164:167], v[68:71]
    ds_read_b64 v[194:195], v5 offset:264
L_pad101:
    s_cbranch_execz L_hop3
    v_mfma_f32_16x16x32_bf16 v[68:71], v[228:231], v[160:163], v[68:71]
    ds_write_b64 v13, v[38:39] offset:2048
    v_mfma_f32_16x16x32_bf16 v[72:75], v[224:227], v[168:171], v[72:75]
    ds_read_b128 v[128:131], v14 offset:768
    v_mfma_f32_16x16x32_bf16 v[72:75], v[228:231], v[164:167], v[72:75]
    ds_read_b64 v[196:197], v5 offset:768
    v_mfma_f32_16x16x32_bf16 v[72:75], v[232:235], v[160:163], v[72:75]
    ds_read_b64 v[198:199], v5 offset:776
    v_mfma_f32_16x16x32_bf16 v[76:79], v[224:227], v[172:175], v[76:79]
    ds_write_b64 v13, v[118:119] offset:6208
    v_mfma_f32_16x16x32_bf16 v[76:79], v[228:231], v[168:171], v[76:79]
    ds_read_b128 v[132:135], v14 offset:2816
    v_mfma_f32_16x16x32_bf16 v[76:79], v[232:235], v[164:167], v[76:79]
    ds_read_b64 v[200:201], v5 offset:1280
    v_mfma_f32_16x16x32_bf16 v[76:79], v[236:239], v[160:163], v[76:79]
    ds_read_b64 v[202:203], v5 offset:1288
    v_mfma_f32_16x16x32_bf16 v[80:83], v[224:227], v[176:179], v[80:83]
    ds_write_b64 v13, v[120:121] offset:10368
    v_mfma_f32_16x16x32_bf16 v[80:83], v[228:231], v[172:175], v[80:83]
    ds_read_b128 v[136:139], v14 offset:4864
    v_mfma_f32_16x16x32_bf16 v[80:83], v[232:235], v[168:171], v[80:83]
    ds_read_b64 v[204:205], v5 offset:1792
    v_mfma_f32_16x16x32_bf16 v[80:83], v[236:239], v[164:167], v[80:83]
    ds_read_b64 v[206:207], v5 offset:1800
    v_mfma_f32_16x16x32_bf16 v[80:83], v[240:243], v[160:163], v[80:83]
    ds_write_b64 v13, v[122:123] offset:14528
    s_waitcnt lgkmcnt(15)
    v_mfma_f32_16x16x32_bf16 v[84:87], v[224:227], v[180:183], v[84:87]
    ds_read_b128 v[140:143], v14 offset:6912
    v_mfma_f32_16x16x32_bf16 v[84:87], v[228:231], v[176:179], v[84:87]
    ds_read_b64 v[208:209], v5 offset:2304
    s_waitcnt vmcnt(16)
    v_mfma_f32_16x16x32_bf16 v[84:87], v[232:235], v[172:175], v[84:87]
    ds_read_b64 v[210:211], v5 offset:2312
    v_alignbit_b32 v24, v42, v41, 16
    v_mfma_f32_16x16x32_bf16 v[84:87], v[236:239], v[168:171], v[84:87]
    buffer_load_dwordx4 v20, s[36:39], s92 offen offset:2048 sc1 lds
    v_mfma_f32_16x16x32_bf16 v[84:87], v[240:243], v[164:167], v[84:87]
    ds_read_b128 v[144:147], v14 offset:8960
    v_alignbit_b32 v25, v43, v42, 16
    v_mfma_f32_16x16x32_bf16 v[84:87], v[244:247], v[160:163], v[84:87]
    ds_read_b64 v[212:213], v5 offset:2816
    v_mov_b32 v26, v41
    v_mfma_f32_16x16x32_bf16 v[88:91], v[224:227], v[184:187], v[88:91]
    ds_read_b64 v[214:215], v5 offset:2824
    v_mov_b32 v27, v42
    v_mfma_f32_16x16x32_bf16 v[88:91], v[228:231], v[180:183], v[88:91]
    buffer_load_dwordx4 v21, s[36:39], s92 offen offset:3072 sc1 lds
    v_mfma_f32_16x16x32_bf16 v[88:91], v[232:235], v[176:179], v[88:91]
    ds_read_b128 v[148:151], v14 offset:11008
    v_alignbit_b32 v28, v41, v40, 16
    v_mfma_f32_16x16x32_bf16 v[88:91], v[236:239], v[172:175], v[88:91]
    ds_read_b64 v[216:217], v5 offset:3328
    v_mov_b32 v29, v24
    v_mfma_f32_16x16x32_bf16 v[88:91], v[240:243], v[168:171], v[88:91]
    ds_read_b64 v[218:219], v5 offset:3336
    v_mfma_f32_16x16x32_bf16 v[88:91], v[244:247], v[164:167], v[88:91]
    buffer_load_dword v6, v7, s[32:35], s94 offen
    v_mfma_f32_16x16x32_bf16 v[88:91], v[248:251], v[160:163], v[88:91]
    ds_read_b128 v[152:155], v14 offset:13056
    v_mfma_f32_16x16x32_bf16 v[92:95], v[224:227], v[188:191], v[92:95]
    ds_read_b64 v[220:221], v5 offset:3840
    v_mfma_f32_16x16x32_bf16 v[92:95], v[228:231], v[184:187], v[92:95]
    ds_read_b64 v[222:223], v5 offset:3848
    v_mfma_f32_16x16x32_bf16 v[92:95], v[232:235], v[180:183], v[92:95]
    ds_read_b128 v[156:159], v14 offset:15104
    v_mfma_f32_16x16x32_bf16 v[92:95], v[236:239], v[176:179], v[92:95]
    v_mfma_f32_16x16x32_bf16 v[92:95], v[240:243], v[172:175], v[92:95]
    v_mfma_f32_16x16x32_bf16 v[92:95], v[244:247], v[168:171], v[92:95]
    v_mfma_f32_16x16x32_bf16 v[92:95], v[248:251], v[164:167], v[92:95]
    v_mfma_f32_16x16x32_bf16 v[92:95], v[252:255], v[160:163], v[92:95]
    s_waitcnt lgkmcnt(9)
    v_mfma_f32_16x16x32_bf16 v[64:67], v[192:195], v[128:131], v[64:67]
    ds_read_b64 v[224:225], v5 offset:320
    v_mfma_f32_16x16x32_bf16 v[68:71], v[192:195], v[132:135], v[68:71]
    ds_read_b64 v[226:227], v5 offset:328
    v_mfma_f32_16x16x32_bf16 v[68:71], v[196:199], v[128:131], v[68:71]
    ds_write_b64 v13, v[42:43] offset:128
    v_mfma_f32_16x16x32_bf16 v[72:75], v[192:195], v[136:139], v[72:75]
    ds_read_b128 v[160:163], v15 offset:512
    v_mfma_f32_16x16x32_bf16 v[72:75], v[196:199], v[132:135], v[72:75]
    ds_read_b64 v[228:229], v5 offset:832
    s_add_u32 s91, s91, 18432
    v_mfma_f32_16x16x32_bf16 v[72:75], v[200:203], v[128:131], v[72:75]
    ds_read_b64 v[230:231], v5 offset:840
    s_cmp_eq_u32 s63, 0
    v_mfma_f32_16x16x32_bf16 v[76:79], v[192:195], v[140:143], v[76:79]
    ds_read_b128 v[164:167], v15 offset:2560
    s_cselect_b32 s91, s91, s72
    v_mfma_f32_16x16x32_bf16 v[76:79], v[196:199], v[136:139], v[76:79]
    ds_write_b64 v13, v[24:25] offset:4288
    v_mfma_f32_16x16x32_bf16 v[76:79], v[200:203], v[132:135], v[76:79]
    ds_read_b64 v[232:233], v5 offset:1344
    s_cselect_b32 s67, 64, s93
    v_mfma_f32_16x16x32_bf16 v[76:79], v[204:207], v[128:131], v[76:79]
    ds_read_b64 v[234:235], v5 offset:1352
    s_add_u32 s92, s92, s67
    v_mfma_f32_16x16x32_bf16 v[80:83], v[192:195], v[144:147], v[80:83]
    ds_read_b128 v[168:171], v15 offset:4608
    v_mfma_f32_16x16x32_bf16 v[80:83], v[196:199], v[140:143], v[80:83]
    ds_read_b64 v[236:237], v5 offset:1856
    v_mfma_f32_16x16x32_bf16 v[80:83], v[200:203], v[136:139], v[80:83]
    ds_write_b64 v13, v[26:27] offset:8448
    v_mfma_f32_16x16x32_bf16 v[80:83], v[204:207], v[132:135], v[80:83]
    ds_read_b64 v[238:239], v5 offset:1864
    v_mfma_f32_16x16x32_bf16 v[80:83], v[208:211], v[128:131], v[80:83]
    ds_read_b128 v[172:175], v15 offset:6656
    s_waitcnt lgkmcnt(15)
    v_mfma_f32_16x16x32_bf16 v[84:87], v[192:195], v[148:151], v[84:87]
    ds_read_b64 v[240:241], v5 offset:2368
    v_mfma_f32_16x16x32_bf16 v[84:87], v[196:199], v[144:147], v[84:87]
    ds_read_b64 v[242:243], v5 offset:2376
    v_mfma_f32_16x16x32_bf16 v[84:87], v[200:203], v[140:143], v[84:87]
    ds_write_b64 v13, v[28:29] offset:12608
    v_mfma_f32_16x16x32_bf16 v[84:87], v[204:207], v[136:139], v[84:87]
    ds_read_b128 v[176:179], v15 offset:8704
    v_mfma_f32_16x16x32_bf16 v[84:87], v[208:211], v[132:135], v[84:87]
    ds_read_b64 v[244:245], v5 offset:2880
    v_mfma_f32_16x16x32_bf16 v[84:87], v[212:215], v[128:131], v[84:87]
    ds_read_b64 v[246:247], v5 offset:2888
    s_waitcnt vmcnt(17)
    v_mfma_f32_16x16x32_bf16 v[88:91], v[192:195], v[152:155], v[88:91]
    ds_read_b128 v[180:183], v15 offset:10752
    v_alignbit_b32 v104, v46, v45, 16
    v_mfma_f32_16x16x32_bf16 v[88:91], v[196:199], v[148:151], v[88:91]
    buffer_load_dwordx2 v[32:33], v9, s[52:55], s76 offen offset:0
    v_mfma_f32_16x16x32_bf16 v[88:91], v[200:203], v[144:147], v[88:91]
    ds_read_b64 v[248:249], v5 offset:3392
    v_alignbit_b32 v105, v47, v46, 16
    v_mfma_f32_16x16x32_bf16 v[88:91], v[204:207], v[140:143], v[88:91]
    ds_read_b64 v[250:251], v5 offset:3400
    v_mov_b32 v106, v45
    v_mfma_f32_16x16x32_bf16 v[88:91], v[208:211], v[136:139], v[88:91]
    ds_read_b128 v[184:187], v15 offset:12800
    v_mov_b32 v107, v46
    v_mfma_f32_16x16x32_bf16 v[88:91], v[212:215], v[132:135], v[88:91]
    ds_read_b64 v[252:253], v5 offset:3904
    v_alignbit_b32 v108, v45, v44, 16
    v_mfma_f32_16x16x32_bf16 v[88:91], v[216:219], v[128:131], v[88:91]
    buffer_load_dwordx2 v[34:35], v8, s[52:55], s76 offen offset:0
    v_mfma_f32_16x16x32_bf16 v[92:95], v[192:195], v[156:159], v[92:95]
    ds_read_b64 v[254:255], v5 offset:3912
    v_mov_b32 v109, v104
    v_mfma_f32_16x16x32_bf16 v[92:95], v[196:199], v[152:155], v[92:95]
    ds_read_b128 v[188:191], v15 offset:14848
    v_mfma_f32_16x16x32_bf16 v[92:95], v[200:203], v[148:151], v[92:95]
    v_mfma_f32_16x16x32_bf16 v[92:95], v[204:207], v[144:147], v[92:95]
    v_mfma_f32_16x16x32_bf16 v[92:95], v[208:211], v[140:143], v[92:95]
    v_mfma_f32_16x16x32_bf16 v[92:95], v[212:215], v[136:139], v[92:95]
    v_mfma_f32_16x16x32_bf16 v[92:95], v[216:219], v[132:135], v[92:95]
    v_mfma_f32_16x16x32_bf16 v[92:95], v[220:223], v[128:131], v[92:95]
    s_waitcnt lgkmcnt(9)
    v_mfma_f32_16x16x32_bf16 v[64:67], v[224:227], v[160:163], v[64:67]
    ds_read_b64 v[192:193], v5 offset:384
    v_mfma_f32_16x16x32_bf16 v[68:71], v[224:227], v[164:167], v[68:71]
    ds_read_b64 v[194:195], v5 offset:392
    v_mfma_f32_16x16x32_bf16 v[68:71], v[228:231], v[160:163], v[68:71]
    ds_write_b64 v13, v[46:47] offset:2176
    v_mfma_f32_16x16x32_bf16 v[72:75], v[224:227], v[168:171], v[72:75]
    ds_read_b128 v[128:131], v16 offset:256
    v_mfma_f32_16x16x32_bf16 v[72:75], v[228:231], v[164:167], v[72:75]
    ds_read_b64 v[196:197], v5 offset:896
    v_mfma_f32_16x16x32_bf16 v[72:75], v[232:235], v[160:163], v[72:75]
    ds_read_b64 v[198:199], v5 offset:904
    v_mfma_f32_16x16x32_bf16 v[76:79], v[224:227], v[172:175], v[76:79]
    ds_read_b128 v[132:135], v16 offset:2304
    v_mfma_f32_16x16x32_bf16 v[76:79], v[228:231], v[168:171], v[76:79]
    ds_write_b64 v13, v[104:105] offset:6336
    v_mfma_f32_16x16x32_bf16 v[76:79], v[232:235], v[164:167], v[76:79]
    ds_read_b64 v[200:201], v5 offset:1408
    s_waitcnt vmcnt(17)
    v_mfma_f32_16x16x32_bf16 v[76:79], v[236:239], v[160:163], v[76:79]
    ds_read_b64 v[202:203], v5 offset:1416
    v_alignbit_b32 v112, v50, v49, 16
    v_mfma_f32_16x16x32_bf16 v[80:83], v[224:227], v[176:179], v[80:83]
    ds_read_b128 v[136:139], v16 offset:4352
    v_alignbit_b32 v113, v51, v50, 16
    v_mfma_f32_16x16x32_bf16 v[80:83], v[228:231], v[172:175], v[80:83]
    ds_read_b64 v[204:205], v5 offset:1920
    v_mov_b32 v114, v49
    v_mfma_f32_16x16x32_bf16 v[80:83], v[232:235], v[168:171], v[80:83]
    ds_write_b64 v13, v[106:107] offset:10496
    v_mfma_f32_16x16x32_bf16 v[80:83], v[236:239], v[164:167], v[80:83]
    ds_read_b64 v[206:207], v5 offset:1928
    v_mov_b32 v115, v50
    v_mfma_f32_16x16x32_bf16 v[80:83], v[240:243], v[160:163], v[80:83]
    ds_read_b128 v[140:143], v16 offset:6400
    v_alignbit_b32 v116, v49, v48, 16
    s_waitcnt lgkmcnt(15)
    v_mfma_f32_16x16x32_bf16 v[84:87], v[224:227], v[180:183], v[84:87]
    ds_read_b64 v[208:209], v5 offset:2432
    v_mov_b32 v117, v112
    v_mfma_f32_16x16x32_bf16 v[84:87], v[228:231], v[176:179], v[84:87]
    ds_read_b64 v[210:211], v5 offset:2440
    s_waitcnt vmcnt(15)
    v_mfma_f32_16x16x32_bf16 v[84:87], v[232:235], v[172:175], v[84:87]
    ds_write_b64 v13, v[108:109] offset:14656
    v_mfma_f32_16x16x32_bf16 v[84:87], v[236:239], v[168:171], v[84:87]
    ds_read_b128 v[144:147], v16 offset:8448
    v_alignbit_b32 v118, v54, v53, 16
    v_mfma_f32_16x16x32_bf16 v[84:87], v[240:243], v[164:167], v[84:87]
    ds_read_b64 v[212:213], v5 offset:2944
    v_alignbit_b32 v119, v55, v54, 16
    v_mfma_f32_16x16x32_bf16 v[84:87], v[244:247], v[160:163], v[84:87]
    ds_read_b64 v[214:215], v5 offset:2952
    v_mov_b32 v120, v53
    v_mfma_f32_16x16x32_bf16 v[88:91], v[224:227], v[184:187], v[88:91]
    ds_read_b128 v[148:151], v16 offset:10496
    v_mov_b32 v121, v54
    v_mfma_f32_16x16x32_bf16 v[88:91], v[228:231], v[180:183], v[88:91]
    buffer_load_dwordx2 v[36:37], v8, s[52:55], s76 offen offset:2040
    v_mfma_f32_16x16x32_bf16 v[88:91], v[232:235], v[176:179], v[88:91]
    ds_read_b64 v[216:217], v5 offset:3456
    v_alignbit_b32 v122, v53, v52, 16
    v_mfma_f32_16x16x32_bf16 v[88:91], v[236:239], v[172:175], v[88:91]
    ds_read_b64 v[218:219], v5 offset:3464
    v_mov_b32 v123, v118
    v_mfma_f32_16x16x32_bf16 v[88:91], v[240:243], v[168:171], v[88:91]
    ds_read_b128 v[152:155], v16 offset:12544
    v_mfma_f32_16x16x32_bf16 v[88:91], v[244:247], v[164:167], v[88:91]
    ds_read_b64 v[220:221], v5 offset:3968
    v_mfma_f32_16x16x32_bf16 v[88:91], v[248:251], v[160:163], v[88:91]
    buffer_load_dwordx2 v[38:39], v8, s[52:55], s76 offen offset:2048
    v_mfma_f32_16x16x32_bf16 v[92:95], v[224:227], v[188:191], v[92:95]
    ds_read_b64 v[222:223], v5 offset:3976
    v_mfma_f32_16x16x32_bf16 v[92:95], v[228:231], v[184:187], v[92:95]
    ds_read_b128 v[156:159], v16 offset:14592
    v_mfma_f32_16x16x32_bf16 v[92:95], v[232:235], v[180:183], v[92:95]
    v_mfma_f32_16x16x32_bf16 v[92:95], v[236:239], v[176:179], v[92:95]
    v_mfma_f32_16x16x32_bf16 v[92:95], v[240:243], v[172:175], v[92:95]
    v_mfma_f32_16x16x32_bf16 v[92:95], v[244:247], v[168:171], v[92:95]
    v_mfma_f32_16x16x32_bf16 v[92:95], v[248:251], v[164:167], v[92:95]
    v_mfma_f32_16x16x32_bf16 v[92:95], v[252:255], v[160:163], v[92:95]
    s_waitcnt lgkmcnt(9)
    v_mfma_f32_16x16x32_bf16 v[64:67], v[192:195], v[128:131], v[64:67]
    ds_read_b64 v[224:225], v5 offset:448
    v_xor_b32 v14, s97, v14
    v_mfma_f32_16x16x32_bf16 v[68:71], v[192:195], v[132:135], v[68:71]
    ds_read_b64 v[226:227], v5 offset:456
    v_add_u32 v14, s79, v14
    v_mfma_f32_16x16x32_bf16 v[68:71], v[196:199], v[128:131], v[68:71]
    ds_write_b64 v13, v[50:51] offset:256
    v_mfma_f32_16x16x32_bf16 v[72:75], v[192:195], v[136:139], v[72:75]
    ds_read_b128 v[160:163], v17 offset:0
    v_xor_b32 v15, s97, v15
    v_mfma_f32_16x16x32_bf16 v[72:75], v[196:199], v[132:135], v[72:75]
    ds_read_b64 v[228:229], v5 offset:960
    v_add_u32 v15, s79, v15
    v_mfma_f32_16x16x32_bf16 v[72:75], v[200:203], v[128:131], v[72:75]
    ds_read_b64 v[230:231], v5 offset:968
    s_waitcnt vmcnt(11)
    v_mfma_f32_16x16x32_bf16 v[76:79], v[192:195], v[140:143], v[76:79]
    ds_write_b64 v13, v[112:113] offset:4416
    v_mfma_f32_16x16x32_bf16 v[76:79], v[196:199], v[136:139], v[76:79]
    ds_read_b128 v[164:167], v17 offset:2048
    v_alignbit_b32 v24, v58, v57, 16
    v_mfma_f32_16x16x32_bf16 v[76:79], v[200:203], v[132:135], v[76:79]
    ds_read_b64 v[232:233], v5 offset:1472
    v_alignbit_b32 v25, v59, v58, 16
    v_mfma_f32_16x16x32_bf16 v[76:79], v[204:207], v[128:131], v[76:79]
    ds_read_b64 v[234:235], v5 offset:1480
    v_mov_b32 v26, v57
    v_mfma_f32_16x16x32_bf16 v[80:83], v[192:195], v[144:147], v[80:83]
    ds_write_b64 v13, v[114:115] offset:8576
    v_mfma_f32_16x16x32_bf16 v[80:83], v[196:199], v[140:143], v[80:83]
    ds_read_b128 v[168:171], v17 offset:4096
    v_mov_b32 v27, v58
    v_mfma_f32_16x16x32_bf16 v[80:83], v[200:203], v[136:139], v[80:83]
    ds_read_b64 v[236:237], v5 offset:1984
    v_alignbit_b32 v28, v57, v56, 16
    v_mfma_f32_16x16x32_bf16 v[80:83], v[204:207], v[132:135], v[80:83]
    ds_read_b64 v[238:239], v5 offset:1992
    v_mov_b32 v29, v24
    v_mfma_f32_16x16x32_bf16 v[80:83], v[208:211], v[128:131], v[80:83]
    ds_write_b64 v13, v[116:117] offset:12736
    s_waitcnt lgkmcnt(15)
    v_mfma_f32_16x16x32_bf16 v[84:87], v[192:195], v[148:151], v[84:87]
    ds_read_b128 v[172:175], v17 offset:6144
    s_waitcnt vmcnt(9)
    v_mfma_f32_16x16x32_bf16 v[84:87], v[196:199], v[144:147], v[84:87]
    ds_read_b64 v[240:241], v5 offset:2496
    v_alignbit_b32 v104, v62, v61, 16
    v_mfma_f32_16x16x32_bf16 v[84:87], v[200:203], v[140:143], v[84:87]
    ds_read_b64 v[242:243], v5 offset:2504
    v_alignbit_b32 v105, v63, v62, 16
    v_mfma_f32_16x16x32_bf16 v[84:87], v[204:207], v[136:139], v[84:87]
    ds_write_b64 v13, v[54:55] offset:2304
    v_mfma_f32_16x16x32_bf16 v[84:87], v[208:211], v[132:135], v[84:87]
    ds_read_b128 v[176:179], v17 offset:8192
    v_mov_b32 v106, v61
    v_mfma_f32_16x16x32_bf16 v[84:87], v[212:215], v[128:131], v[84:87]
    ds_read_b64 v[244:245], v5 offset:3008
    v_mov_b32 v107, v62
    v_mfma_f32_16x16x32_bf16 v[88:91], v[192:195], v[152:155], v[88:91]
    ds_read_b64 v[246:247], v5 offset:3016
    v_alignbit_b32 v108, v61, v60, 16
    v_mfma_f32_16x16x32_bf16 v[88:91], v[196:199], v[148:151], v[88:91]
    ds_write_b64 v13, v[118:119] offset:6464
    v_mfma_f32_16x16x32_bf16 v[88:91], v[200:203], v[144:147], v[88:91]
    ds_read_b128 v[180:183], v17 offset:10240
    v_mov_b32 v109, v104
    v_mfma_f32_16x16x32_bf16 v[88:91], v[204:207], v[140:143], v[88:91]
    ds_read_b64 v[248:249], v5 offset:3520
    v_xor_b32 v16, s97, v16
    v_mfma_f32_16x16x32_bf16 v[88:91], v[208:211], v[136:139], v[88:91]
    ds_read_b64 v[250:251], v5 offset:3528
    v_add_u32 v16, s79, v16
    v_mfma_f32_16x16x32_bf16 v[88:91], v[212:215], v[132:135], v[88:91]
    ds_write_b64 v13, v[120:121] offset:10624
    v_mfma_f32_16x16x32_bf16 v[88:91], v[216:219], v[128:131], v[88:91]
    ds_read_b128 v[184:187], v17 offset:12288
    v_mfma_f32_16x16x32_bf16 v[92:95], v[192:195], v[156:159], v[92:95]
    ds_read_b64 v[252:253], v5 offset:4032
    v_mfma_f32_16x16x32_bf16 v[92:95], v[196:199], v[152:155], v[92:95]
    ds_read_b64 v[254:255], v5 offset:4040
    v_mfma_f32_16x16x32_bf16 v[92:95], v[200:203], v[148:151], v[92:95]
    ds_write_b64 v13, v[122:123] offset:14784
    v_mfma_f32_16x16x32_bf16 v[92:95], v[204:207], v[144:147], v[92:95]
    ds_read_b128 v[188:191], v17 offset:14336
    v_mfma_f32_16x16x32_bf16 v[92:95], v[208:211], v[140:143], v[92:95]
    buffer_load_dwordx2 v[40:41], v8, s[52:55], s76 offen offset:120
    v_mfma_f32_16x16x32_bf16 v[92:95], v[212:215], v[136:139], v[92:95]
    buffer_load_dwordx2 v[42:43], v8, s[52:55], s76 offen offset:128
    v_mfma_f32_16x16x32_bf16 v[92:95], v[216:219], v[132:135], v[92:95]
    v_add_u32 v5, s87, v5
    v_xor_b32 v17, s97, v17
    v_mfma_f32_16x16x32_bf16 v[92:95], v[220:223], v[128:131], v[92:95]
    v_add_u32 v17, s79, v17
    s_waitcnt vmcnt(7)
    s_barrier
    s_waitcnt lgkmcnt(12)
    v_mfma_f32_16x16x32_bf16 v[64:67], v[224:227], v[160:163], v[64:67]
    ds_write_b64 v13, v[58:59] offset:384
    v_mfma_f32_16x16x32_bf16 v[68:71], v[224:227], v[164:167], v[68:71]
    ds_read_b128 v[128:131], v14 offset:1792
    s_mov_b32 s90, s82
    v_mfma_f32_16x16x32_bf16 v[68:71], v[228:231], v[160:163], v[68:71]
    ds_write_b64 v13, v[24:25] offset:4544
    v_mfma_f32_16x16x32_bf16 v[72:75], v[224:227], v[168:171], v[72:75]
    ds_read_b128 v[132:135], v14 offset:3840
    s_mov_b32 s82, s83
    v_mfma_f32_16x16x32_bf16 v[72:75], v[228:231], v[164:167], v[72:75]
    ds_write_b64 v13, v[26:27] offset:8704
    v_mfma_f32_16x16x32_bf16 v[72:75], v[232:235], v[160:163], v[72:75]
    ds_read_b128 v[136:139], v14 offset:5888
    s_mov_b32 s83, s84
    v_mfma_f32_16x16x32_bf16 v[76:79], v[224:227], v[172:175], v[76:79]
    ds_write_b64 v13, v[28:29] offset:12864
    v_mfma_f32_16x16x32_bf16 v[76:79], v[228:231], v[168:171], v[76:79]
    ds_read_b128 v[140:143], v14 offset:7936
    s_mov_b32 s84, s85
    v_mfma_f32_16x16x32_bf16 v[76:79], v[232:235], v[164:167], v[76:79]
    ds_write_b64 v13, v[62:63] offset:2432
    v_mfma_f32_16x16x32_bf16 v[76:79], v[236:239], v[160:163], v[76:79]
    ds_read_b128 v[144:147], v14 offset:9984
    s_mov_b32 s79, s80
    v_mfma_f32_16x16x32_bf16 v[80:83], v[224:227], v[176:179], v[80:83]
    ds_write_b64 v13, v[104:105] offset:6592
    v_mfma_f32_16x16x32_bf16 v[80:83], v[228:231], v[172:175], v[80:83]
    ds_read_b128 v[148:151], v14 offset:12032
    s_mov_b32 s80, s81
    v_mfma_f32_16x16x32_bf16 v[80:83], v[232:235], v[168:171], v[80:83]
    ds_write_b64 v13, v[106:107] offset:10752
    v_mfma_f32_16x16x32_bf16 v[80:83], v[236:239], v[164:167], v[80:83]
    ds_read_b128 v[152:155], v14 offset:14080
    s_mov_b32 s87, s88
    v_mfma_f32_16x16x32_bf16 v[80:83], v[240:243], v[160:163], v[80:83]
    ds_write_b64 v13, v[108:109] offset:14912
    s_waitcnt lgkmcnt(15)
    v_mfma_f32_16x16x32_bf16 v[84:87], v[224:227], v[180:183], v[84:87]
    ds_read_b128 v[156:159], v14 offset:16128
    s_mov_b32 s88, s89
    v_mfma_f32_16x16x32_bf16 v[84:87], v[228:231], v[176:179], v[84:87]
    ds_read_b64 v[192:193], v5 offset:0
    v_cvt_pk_bf16_f32 v96, v64, v65
    v_mfma_f32_16x16x32_bf16 v[84:87], v[232:235], v[172:175], v[84:87]
    ds_read_b64 v[194:195], v5 offset:8
    v_cvt_pk_bf16_f32 v97, v66, v67
    v_mfma_f32_16x16x32_bf16 v[84:87], v[236:239], v[168:171], v[84:87]
    ds_read_b64 v[196:197], v5 offset:512
    v_cvt_pk_bf16_f32 v98, v68, v69
    v_mfma_f32_16x16x32_bf16 v[84:87], v[240:243], v[164:167], v[84:87]
    ds_read_b64 v[198:199], v5 offset:520
    v_cvt_pk_bf16_f32 v99, v70, v71
    v_mfma_f32_16x16x32_bf16 v[84:87], v[244:247], v[160:163], v[84:87]
    ds_read_b64 v[200:201], v5 offset:1024
    v_cvt_pk_bf16_f32 v100, v72, v73
    v_mfma_f32_16x16x32_bf16 v[88:91], v[224:227], v[184:187], v[88:91]
    ds_read_b64 v[202:203], v5 offset:1032
    v_cvt_pk_bf16_f32 v101, v74, v75
    v_mfma_f32_16x16x32_bf16 v[88:91], v[228:231], v[180:183], v[88:91]
    ds_read_b64 v[204:205], v5 offset:1536
    v_cvt_pk_bf16_f32 v102, v76, v77
    v_mfma_f32_16x16x32_bf16 v[88:91], v[232:235], v[176:179], v[88:91]
    ds_read_b64 v[206:207], v5 offset:1544
    v_cvt_pk_bf16_f32 v103, v78, v79
    v_mfma_f32_16x16x32_bf16 v[88:91], v[236:239], v[172:175], v[88:91]
    ds_read_b64 v[208:209], v5 offset:2048
    s_mov_b32 s97, s98
    v_mfma_f32_16x16x32_bf16 v[88:91], v[240:243], v[168:171], v[88:91]
    ds_read_b64 v[210:211], v5 offset:2056
    s_mov_b32 s98, s99
    v_mfma_f32_16x16x32_bf16 v[88:91], v[244:247], v[164:167], v[88:91]
    ds_read_b64 v[212:213], v5 offset:2560
    s_mov_b32 s75, s76
    v_mfma_f32_16x16x32_bf16 v[88:91], v[248:251], v[160:163], v[88:91]
    ds_read_b64 v[214:215], v5 offset:2568
    s_add_u32 s63, s63, 1
    v_mfma_f32_16x16x32_bf16 v[92:95], v[224:227], v[188:191], v[92:95]
    ds_read_b64 v[216:217], v5 offset:3072
    s_cmp_lt_u32 s63, 3
    v_mfma_f32_16x16x32_bf16 v[92:95], v[228:231], v[184:187], v[92:95]
    ds_read_b64 v[218:219], v5 offset:3080
    v_mfma_f32_16x16x32_bf16 v[92:95], v[232:235], v[180:183], v[92:95]
    ds_read_b64 v[220:221], v5 offset:3584
    v_mfma_f32_16x16x32_bf16 v[92:95], v[236:239], v[176:179], v[92:95]
    ds_read_b64 v[222:223], v5 offset:3592
    v_mfma_f32_16x16x32_bf16 v[92:95], v[240:243], v[172:175], v[92:95]
    buffer_load_dwordx2 v[44:45], v8, s[52:55], s76 offen offset:2168
    v_mfma_f32_16x16x32_bf16 v[92:95], v[244:247], v[168:171], v[92:95]
    buffer_load_dwordx2 v[46:47], v8, s[52:55], s76 offen offset:2176
    v_mfma_f32_16x16x32_bf16 v[92:95], v[248:251], v[164:167], v[92:95]
    s_mov_b32 s76, s77
    s_mov_b32 s77, 0x7fff0000
    v_mfma_f32_16x16x32_bf16 v[92:95], v[252:255], v[160:163], v[92:95]
    s_cbranch_scc1 L_conv
    s_waitcnt lgkmcnt(6)
    v_mfma_f32_16x16x32_bf16 v[64:67], v[192:195], v[128:131], 0
    ds_read_b64 v[224:225], v5 offset:64
    v_mfma_f32_16x16x32_bf16 v[68:71], v[192:195], v[132:135], 0
    ds_read_b64 v[226:227], v5 offset:72
    v_mfma_f32_16x16x32_bf16 v[68:71], v[196:199], v[128:131], v[68:71]
    ds_read_b128 v[160:163], v15 offset:1536
    v_mfma_f32_16x16x32_bf16 v[72:75], v[192:195], v[136:139], 0
    ds_read_b64 v[228:229], v5 offset:576
    v_cvt_pk_bf16_f32 v104, v80, v81
    v_mfma_f32_16x16x32_bf16 v[72:75], v[196:199], v[132:135], v[72:75]
    ds_read_b64 v[230:231], v5 offset:584
    v_cvt_pk_bf16_f32 v105, v82, v83
    v_mfma_f32_16x16x32_bf16 v[72:75], v[200:203], v[128:131], v[72:75]
    ds_read_b128 v[164:167], v15 offset:3584
    v_cvt_pk_bf16_f32 v106, v84, v85
    v_mfma_f32_16x16x32_bf16 v[76:79], v[192:195], v[140:143], 0
    ds_read_b64 v[232:233], v5 offset:1088
    v_cvt_pk_bf16_f32 v107, v86, v87
    v_mfma_f32_16x16x32_bf16 v[76:79], v[196:199], v[136:139], v[76:79]
    ds_read_b64 v[234:235], v5 offset:1096
    v_permlane16_swap_b32 v96, v98
    v_mfma_f32_16x16x32_bf16 v[76:79], v[200:203], v[132:135], v[76:79]
    ds_read_b128 v[168:171], v15 offset:5632
    v_permlane16_swap_b32 v97, v99
    v_mfma_f32_16x16x32_bf16 v[76:79], v[204:207], v[128:131], v[76:79]
    ds_read_b64 v[236:237], v5 offset:1600
    v_permlane16_swap_b32 v100, v102
    v_mfma_f32_16x16x32_bf16 v[80:83], v[192:195], v[144:147], 0
    ds_read_b64 v[238:239], v5 offset:1608
    v_permlane16_swap_b32 v101, v103
    v_mfma_f32_16x16x32_bf16 v[80:83], v[196:199], v[140:143], v[80:83]
    ds_read_b128 v[172:175], v15 offset:7680
    v_cvt_pk_bf16_f32 v108, v88, v89
    v_mfma_f32_16x16x32_bf16 v[80:83], v[200:203], v[136:139], v[80:83]
    ds_read_b64 v[240:241], v5 offset:2112
    v_cvt_pk_bf16_f32 v109, v90, v91
    v_mfma_f32_16x16x32_bf16 v[80:83], v[204:207], v[132:135], v[80:83]
    ds_read_b64 v[242:243], v5 offset:2120
    v_cvt_pk_bf16_f32 v110, v92, v93
    v_mfma_f32_16x16x32_bf16 v[80:83], v[208:211], v[128:131], v[80:83]
    ds_read_b128 v[176:179], v15 offset:9728
    v_cvt_pk_bf16_f32 v111, v94, v95
    s_waitcnt lgkmcnt(15)
    v_mfma_f32_16x16x32_bf16 v[84:87], v[192:195], v[148:151], 0
    ds_read_b64 v[244:245], v5 offset:2624
    v_permlane16_swap_b32 v104, v106
    v_mfma_f32_16x16x32_bf16 v[84:87], v[196:199], v[144:147], v[84:87]
    ds_read_b64 v[246:247], v5 offset:2632
    v_permlane16_swap_b32 v105, v107
    v_mfma_f32_16x16x32_bf16 v[84:87], v[200:203], v[140:143], v[84:87]
    ds_read_b128 v[180:183], v15 offset:11776
    v_permlane16_swap_b32 v108, v110
    v_mfma_f32_16x16x32_bf16 v[84:87], v[204:207], v[136:139], v[84:87]
    ds_read_b64 v[248:249], v5 offset:3136
    v_permlane16_swap_b32 v109, v111
    v_mfma_f32_16x16x32_bf16 v[84:87], v[208:211], v[132:135], v[84:87]
    ds_read_b64 v[250:251], v5 offset:3144
    v_mfma_f32_16x16x32_bf16 v[84:87], v[212:215], v[128:131], v[84:87]
    ds_read_b128 v[184:187], v15 offset:13824
    v_mfma_f32_16x16x32_bf16 v[88:91], v[192:195], v[152:155], 0
    ds_read_b64 v[252:253], v5 offset:3648
    v_mfma_f32_16x16x32_bf16 v[88:91], v[196:199], v[148:151], v[88:91]
    ds_read_b64 v[254:255], v5 offset:3656
    v_mfma_f32_16x16x32_bf16 v[88:91], v[200:203], v[144:147], v[88:91]
    ds_read_b128 v[188:191], v15 offset:15872
    v_mfma_f32_16x16x32_bf16 v[88:91], v[204:207], v[140:143], v[88:91]
    buffer_store_dwordx4 v[96:99], v12, s[36:39], s90 offen offset:0 sc1
    v_mfma_f32_16x16x32_bf16 v[88:91], v[208:211], v[136:139], v[88:91]
    v_mfma_f32_16x16x32_bf16 v[88:91], v[212:215], v[132:135], v[88:91]
    v_mfma_f32_16x16x32_bf16 v[88:91], v[216:219], v[128:131], v[88:91]
    v_mfma_f32_16x16x32_bf16 v[92:95], v[192:195], v[156:159], 0
    v_mfma_f32_16x16x32_bf16 v[92:95], v[196:199], v[152:155], v[92:95]
    buffer_store_dwordx4 v[100:103], v12, s[36:39], s90 offen offset:1024 sc1
    v_mfma_f32_16x16x32_bf16 v[92:95], v[200:203], v[148:151], v[92:95]
    v_mfma_f32_16x16x32_bf16 v[92:95], v[204:207], v[144:147], v[92:95]
    v_mfma_f32_16x16x32_bf16 v[92:95], v[208:211], v[140:143], v[92:95]
    v_mfma_f32_16x16x32_bf16 v[92:95], v[212:215], v[136:139], v[92:95]
    v_mfma_f32_16x16x32_bf16 v[92:95], v[216:219], v[132:135], v[92:95]
    v_mfma_f32_16x16x32_bf16 v[92:95], v[220:223], v[128:131], v[92:95]
    s_waitcnt lgkmcnt(9)
    v_mfma_f32_16x16x32_bf16 v[64:67], v[224:227], v[160:163], v[64:67]
    ds_read_b64 v[192:193], v5 offset:128
    v_mfma_f32_16x16x32_bf16 v[68:71], v[224:227], v[164:167], v[68:71]
    ds_read_b64 v[194:195], v5 offset:136
    v_mfma_f32_16x16x32_bf16 v[68:71], v[228:231], v[160:163], v[68:71]
    buffer_store_dwordx4 v[104:107], v12, s[36:39], s90 offen offset:2048 sc1
    v_mfma_f32_16x16x32_bf16 v[72:75], v[224:227], v[168:171], v[72:75]
    ds_read_b128 v[128:131], v16 offset:1280
    v_mfma_f32_16x16x32_bf16 v[72:75], v[228:231], v[164:167], v[72:75]
    ds_read_b64 v[196:197], v5 offset:640
    v_mfma_f32_16x16x32_bf16 v[72:75], v[232:235], v[160:163], v[72:75]
    ds_read_b64 v[198:199], v5 offset:648
    v_mfma_f32_16x16x32_bf16 v[76:79], v[224:227], v[172:175], v[76:79]
    ds_read_b128 v[132:135], v16 offset:3328
    v_mfma_f32_16x16x32_bf16 v[76:79], v[228:231], v[168:171], v[76:79]
    buffer_store_dwordx4 v[108:111], v12, s[36:39], s90 offen offset:3072 sc1
    v_mfma_f32_16x16x32_bf16 v[76:79], v[232:235], v[164:167], v[76:79]
    ds_read_b64 v[200:201], v5 offset:1152
    v_mfma_f32_16x16x32_bf16 v[76:79], v[236:239], v[160:163], v[76:79]
    ds_read_b64 v[202:203], v5 offset:1160
    v_mfma_f32_16x16x32_bf16 v[80:83], v[224:227], v[176:179], v[80:83]
    ds_read_b128 v[136:139], v16 offset:5376
    v_mfma_f32_16x16x32_bf16 v[80:83], v[228:231], v[172:175], v[80:83]
    ds_read_b64 v[204:205], v5 offset:1664
    v_mfma_f32_16x16x32_bf16 v[80:83], v[232:235], v[168:171], v[80:83]
    ds_read_b64 v[206:207], v5 offset:1672
    v_mfma_f32_16x16x32_bf16 v[80:83], v[236:239], v[164:167], v[80:83]
    ds_read_b128 v[140:143], v16 offset:7424
    v_mfma_f32_16x16x32_bf16 v[80:83], v[240:243], v[160:163], v[80:83]
    ds_read_b64 v[208:209], v5 offset:2176
    s_waitcnt lgkmcnt(13)
    v_mfma_f32_16x16x32_bf16 v[84:87], v[224:227], v[180:183], v[84:87]
    ds_read_b64 v[210:211], v5 offset:2184
    v_mfma_f32_16x16x32_bf16 v[84:87], v[228:231], v[176:179], v[84:87]
    ds_read_b128 v[144:147], v16 offset:9472
    v_mfma_f32_16x16x32_bf16 v[84:87], v[232:235], v[172:175], v[84:87]
    ds_read_b64 v[212:213], v5 offset:2688
    v_mfma_f32_16x16x32_bf16 v[84:87], v[236:239], v[168:171], v[84:87]
    ds_read_b64 v[214:215], v5 offset:2696
    v_mfma_f32_16x16x32_bf16 v[84:87], v[240:243], v[164:167], v[84:87]
    ds_read_b128 v[148:151], v16 offset:11520
    v_mfma_f32_16x16x32_bf16 v[84:87], v[244:247], v[160:163], v[84:87]
L_pad102:
    s_cbranch_execz L_hop3
    ds_read_b64 v[216:217], v5 offset:3200
    v_mfma_f32_16x16x32_bf16 v[88:91], v[224:227], v[184:187], v[88:91]
    ds_read_b64 v[218:219], v5 offset:3208
    v_mfma_f32_16x16x32_bf16 v[88:91], v[228:231], v[180:183], v[88:91]
    ds_read_b128 v[152:155], v16 offset:13568
    v_mfma_f32_16x16x32_bf16 v[88:91], v[232:235], v[176:179], v[88:91]
    ds_read_b64 v[220:221], v5 offset:3712
    v_mfma_f32_16x16x32_bf16 v[88:91], v[236:239], v[172:175], v[88:91]
    ds_read_b64 v[222:223], v5 offset:3720
    v_mfma_f32_16x16x32_bf16 v[88:91], v[240:243], v[168:171], v[88:91]
    ds_read_b128 v[156:159], v16 offset:15616
    v_mfma_f32_16x16x32_bf16 v[88:91], v[244:247], v[164:167], v[88:91]
    v_mfma_f32_16x16x32_bf16 v[88:91], v[248:251], v[160:163], v[88:91]
    v_mfma_f32_16x16x32_bf16 v[92:95], v[224:227], v[188:191], v[92:95]
    v_mfma_f32_16x16x32_bf16 v[92:95], v[228:231], v[184:187], v[92:95]
    v_mfma_f32_16x16x32_bf16 v[92:95], v[232:235], v[180:183], v[92:95]
    v_mfma_f32_16x16x32_bf16 v[92:95], v[236:239], v[176:179], v[92:95]
    v_mfma_f32_16x16x32_bf16 v[92:95], v[240:243], v[172:175], v[92:95]
    v_mfma_f32_16x16x32_bf16 v[92:95], v[244:247], v[168:171], v[92:95]
    v_mfma_f32_16x16x32_bf16 v[92:95], v[248:251], v[164:167], v[92:95]
    v_mfma_f32_16x16x32_bf16 v[92:95], v[252:255], v[160:163], v[92:95]
    s_waitcnt lgkmcnt(9)
    v_mfma_f32_16x16x32_bf16 v[64:67], v[192:195], v[128:131], v[64:67]
    ds_read_b64 v[224:225], v5 offset:192
    v_mfma_f32_16x16x32_bf16 v[68:71], v[192:195], v[132:135], v[68:71]
    ds_read_b64 v[226:227], v5 offset:200
    v_mfma_f32_16x16x32_bf16 v[68:71], v[196:199], v[128:131], v[68:71]
    ds_read_b128 v[160:163], v17 offset:1024
    v_mfma_f32_16x16x32_bf16 v[72:75], v[192:195], v[136:139], v[72:75]
    ds_read_b64 v[228:229], v5 offset:704
    v_mfma_f32_16x16x32_bf16 v[72:75], v[196:199], v[132:135], v[72:75]
    ds_read_b64 v[230:231], v5 offset:712
    v_mfma_f32_16x16x32_bf16 v[72:75], v[200:203], v[128:131], v[72:75]
    ds_read_b128 v[164:167], v17 offset:3072
    v_mfma_f32_16x16x32_bf16 v[76:79], v[192:195], v[140:143], v[76:79]
    ds_read_b64 v[232:233], v5 offset:1216
    v_mfma_f32_16x16x32_bf16 v[76:79], v[196:199], v[136:139], v[76:79]
    ds_read_b64 v[234:235], v5 offset:1224
    v_mfma_f32_16x16x32_bf16 v[76:79], v[200:203], v[132:135], v[76:79]
    ds_read_b128 v[168:171], v17 offset:5120
    v_mfma_f32_16x16x32_bf16 v[76:79], v[204:207], v[128:131], v[76:79]
    ds_read_b64 v[236:237], v5 offset:1728
    v_mfma_f32_16x16x32_bf16 v[80:83], v[192:195], v[144:147], v[80:83]
    ds_read_b64 v[238:239], v5 offset:1736
    v_mfma_f32_16x16x32_bf16 v[80:83], v[196:199], v[140:143], v[80:83]
    ds_read_b128 v[172:175], v17 offset:7168
    v_mfma_f32_16x16x32_bf16 v[80:83], v[200:203], v[136:139], v[80:83]
    ds_read_b64 v[240:241], v5 offset:2240
    v_mfma_f32_16x16x32_bf16 v[80:83], v[204:207], v[132:135], v[80:83]
    ds_read_b64 v[242:243], v5 offset:2248
    v_mfma_f32_16x16x32_bf16 v[80:83], v[208:211], v[128:131], v[80:83]
    ds_read_b128 v[176:179], v17 offset:9216
    s_waitcnt lgkmcnt(15)
    v_mfma_f32_16x16x32_bf16 v[84:87], v[192:195], v[148:151], v[84:87]
    ds_read_b64 v[244:245], v5 offset:2752
    v_mfma_f32_16x16x32_bf16 v[84:87], v[196:199], v[144:147], v[84:87]
    ds_read_b64 v[246:247], v5 offset:2760
    v_mfma_f32_16x16x32_bf16 v[84:87], v[200:203], v[140:143], v[84:87]
    ds_read_b128 v[180:183], v17 offset:11264
    v_mfma_f32_16x16x32_bf16 v[84:87], v[204:207], v[136:139], v[84:87]
    ds_read_b64 v[248:249], v5 offset:3264
    v_mfma_f32_16x16x32_bf16 v[84:87], v[208:211], v[132:135], v[84:87]
    ds_read_b64 v[250:251], v5 offset:3272
    v_mfma_f32_16x16x32_bf16 v[84:87], v[212:215], v[128:131], v[84:87]
    ds_read_b128 v[184:187], v17 offset:13312
    v_mfma_f32_16x16x32_bf16 v[88:91], v[192:195], v[152:155], v[88:91]
    ds_read_b64 v[252:253], v5 offset:3776
    v_mfma_f32_16x16x32_bf16 v[88:91], v[196:199], v[148:151], v[88:91]
    ds_read_b64 v[254:255], v5 offset:3784
    v_mfma_f32_16x16x32_bf16 v[88:91], v[200:203], v[144:147], v[88:91]
    ds_read_b128 v[188:191], v17 offset:15360
    v_mfma_f32_16x16x32_bf16 v[88:91], v[204:207], v[140:143], v[88:91]
    v_mfma_f32_16x16x32_bf16 v[88:91], v[208:211], v[136:139], v[88:91]
    v_mfma_f32_16x16x32_bf16 v[88:91], v[212:215], v[132:135], v[88:91]
    v_mfma_f32_16x16x32_bf16 v[88:91], v[216:219], v[128:131], v[88:91]
    v_mfma_f32_16x16x32_bf16 v[92:95], v[192:195], v[156:159], v[92:95]
    v_mfma_f32_16x16x32_bf16 v[92:95], v[196:199], v[152:155], v[92:95]
    v_mfma_f32_16x16x32_bf16 v[92:95], v[200:203], v[148:151], v[92:95]
    v_mfma_f32_16x16x32_bf16 v[92:95], v[204:207], v[144:147], v[92:95]
    v_mfma_f32_16x16x32_bf16 v[92:95], v[208:211], v[140:143], v[92:95]
    v_mfma_f32_16x16x32_bf16 v[92:95], v[212:215], v[136:139], v[92:95]
    v_mfma_f32_16x16x32_bf16 v[92:95], v[216:219], v[132:135], v[92:95]
    v_mfma_f32_16x16x32_bf16 v[92:95], v[220:223], v[128:131], v[92:95]
    s_waitcnt lgkmcnt(9)
    v_mfma_f32_16x16x32_bf16 v[64:67], v[224:227], v[160:163], v[64:67]
    v_mfma_f32_16x16x32_bf16 v[68:71], v[224:227], v[164:167], v[68:71]
    v_mfma_f32_16x16x32_bf16 v[68:71], v[228:231], v[160:163], v[68:71]
    v_mfma_f32_16x16x32_bf16 v[72:75], v[224:227], v[168:171], v[72:75]
    v_mfma_f32_16x16x32_bf16 v[72:75], v[228:231], v[164:167], v[72:75]
    v_mfma_f32_16x16x32_bf16 v[72:75], v[232:235], v[160:163], v[72:75]
    v_mfma_f32_16x16x32_bf16 v[76:79], v[224:227], v[172:175], v[76:79]
    v_mfma_f32_16x16x32_bf16 v[76:79], v[228:231], v[168:171], v[76:79]
    v_mfma_f32_16x16x32_bf16 v[76:79], v[232:235], v[164:167], v[76:79]
    v_mfma_f32_16x16x32_bf16 v[76:79], v[236:239], v[160:163], v[76:79]
    v_mfma_f32_16x16x32_bf16 v[80:83], v[224:227], v[176:179], v[80:83]
    v_mfma_f32_16x16x32_bf16 v[80:83], v[228:231], v[172:175], v[80:83]
    v_mfma_f32_16x16x32_bf16 v[80:83], v[232:235], v[168:171], v[80:83]
    v_mfma_f32_16x16x32_bf16 v[80:83], v[236:239], v[164:167], v[80:83]
    v_mfma_f32_16x16x32_bf16 v[80:83], v[240:243], v[160:163], v[80:83]
    s_waitcnt lgkmcnt(0)
    v_mfma_f32_16x16x32_bf16 v[84:87], v[224:227], v[180:183], v[84:87]
    v_mfma_f32_16x16x32_bf16 v[84:87], v[228:231], v[176:179], v[84:87]
    v_mfma_f32_16x16x32_bf16 v[84:87], v[232:235], v[172:175], v[84:87]
    v_mfma_f32_16x16x32_bf16 v[84:87], v[236:239], v[168:171], v[84:87]
    v_mfma_f32_16x16x32_bf16 v[84:87], v[240:243], v[164:167], v[84:87]
    v_mfma_f32_16x16x32_bf16 v[84:87], v[244:247], v[160:163], v[84:87]
    v_mfma_f32_16x16x32_bf16 v[88:91], v[224:227], v[184:187], v[88:91]
    v_mfma_f32_16x16x32_bf16 v[88:91], v[228:231], v[180:183], v[88:91]
    v_mfma_f32_16x16x32_bf16 v[88:91], v[232:235], v[176:179], v[88:91]
    v_mfma_f32_16x16x32_bf16 v[88:91], v[236:239], v[172:175], v[88:91]
    v_mfma_f32_16x16x32_bf16 v[88:91], v[240:243], v[168:171], v[88:91]
    v_mfma_f32_16x16x32_bf16 v[88:91], v[244:247], v[164:167], v[88:91]
    v_mfma_f32_16x16x32_bf16 v[88:91], v[248:251], v[160:163], v[88:91]
    v_mfma_f32_16x16x32_bf16 v[92:95], v[224:227], v[188:191], v[92:95]
    v_mfma_f32_16x16x32_bf16 v[92:95], v[228:231], v[184:187], v[92:95]
    v_mfma_f32_16x16x32_bf16 v[92:95], v[232:235], v[180:183], v[92:95]
    v_mfma_f32_16x16x32_bf16 v[92:95], v[236:239], v[176:179], v[92:95]
    v_mfma_f32_16x16x32_bf16 v[92:95], v[240:243], v[172:175], v[92:95]
    v_mfma_f32_16x16x32_bf16 v[92:95], v[244:247], v[168:171], v[92:95]
    v_mfma_f32_16x16x32_bf16 v[92:95], v[248:251], v[164:167], v[92:95]
    v_mfma_f32_16x16x32_bf16 v[92:95], v[252:255], v[160:163], v[92:95]
    v_cndmask_b32 v128, v80, v64, vcc
    v_cndmask_b32 v129, v81, v65, vcc
    v_cndmask_b32 v130, v82, v66, vcc
    v_cndmask_b32 v131, v83, v67, vcc
    v_cndmask_b32 v132, v84, v68, vcc
    v_cndmask_b32 v133, v85, v69, vcc
    v_cndmask_b32 v134, v86, v70, vcc
    v_cndmask_b32 v135, v87, v71, vcc
    v_cndmask_b32 v136, v88, v72, vcc
    v_cndmask_b32 v137, v89, v73, vcc
    v_cndmask_b32 v138, v90, v74, vcc
    v_cndmask_b32 v139, v91, v75, vcc
    v_cndmask_b32 v140, v92, v76, vcc
    v_cndmask_b32 v141, v93, v77, vcc
    v_cndmask_b32 v142, v94, v78, vcc
    v_cndmask_b32 v143, v95, v79, vcc
    ds_write_b128 v10, v[128:131] offset:0
    ds_write_b128 v10, v[132:135] offset:1024
    ds_write_b128 v10, v[136:139] offset:2048
    ds_write_b128 v10, v[140:143] offset:3072
    v_cndmask_b32 v144, v64, v80, vcc
    v_cndmask_b32 v145, v65, v81, vcc
    v_cndmask_b32 v146, v66, v82, vcc
    v_cndmask_b32 v147, v67, v83, vcc
    v_cndmask_b32 v148, v68, v84, vcc
    v_cndmask_b32 v149, v69, v85, vcc
    v_cndmask_b32 v150, v70, v86, vcc
    v_cndmask_b32 v151, v71, v87, vcc
    v_cndmask_b32 v152, v72, v88, vcc
    v_cndmask_b32 v153, v73, v89, vcc
    v_cndmask_b32 v154, v74, v90, vcc
    v_cndmask_b32 v155, v75, v91, vcc
    v_cndmask_b32 v156, v76, v92, vcc
    v_cndmask_b32 v157, v77, v93, vcc
    v_cndmask_b32 v158, v78, v94, vcc
    v_cndmask_b32 v159, v79, v95, vcc
    s_waitcnt lgkmcnt(0)
    s_barrier
    ds_read_b128 v[128:131], v11 offset:0
    ds_read_b128 v[132:135], v11 offset:1024
    ds_read_b128 v[136:139], v11 offset:2048
    ds_read_b128 v[140:143], v11 offset:3072
    s_waitcnt lgkmcnt(0)
    v_pk_add_f32 v[128:129], v[128:129], v[144:145]
    v_pk_add_f32 v[130:131], v[130:131], v[146:147]
    v_pk_add_f32 v[132:133], v[132:133], v[148:149]
    v_pk_add_f32 v[134:135], v[134:135], v[150:151]
    v_pk_add_f32 v[136:137], v[136:137], v[152:153]
    v_pk_add_f32 v[138:139], v[138:139], v[154:155]
    v_pk_add_f32 v[140:141], v[140:141], v[156:157]
    v_pk_add_f32 v[142:143], v[142:143], v[158:159]
    v_cvt_pk_bf16_f32 v96, v128, v129
    v_cvt_pk_bf16_f32 v97, v130, v131
    v_cvt_pk_bf16_f32 v98, v132, v133
    v_cvt_pk_bf16_f32 v99, v134, v135
    v_cvt_pk_bf16_f32 v100, v136, v137
    v_cvt_pk_bf16_f32 v101, v138, v139
    v_cvt_pk_bf16_f32 v102, v140, v141
    v_cvt_pk_bf16_f32 v103, v142, v143
    v_permlane16_swap_b32 v96, v98
    v_permlane16_swap_b32 v97, v99
    v_permlane16_swap_b32 v100, v102
    v_permlane16_swap_b32 v101, v103
    buffer_store_dwordx4 v[96:99], v12, s[36:39], s82 offen offset:0 sc1
    buffer_store_dwordx4 v[100:103], v12, s[36:39], s82 offen offset:1024 sc1
    s_waitcnt vmcnt(0)
    s_barrier
    v_lshlrev_b32 v6, 2, v1
    s_mov_b32 exec_hi, 0
    buffer_store_dword v3, v6, s[36:39], s62 offen sc1
    s_mov_b32 exec_hi, -1
    s_lshl_b32 s69, s60, 2
    s_add_u32 s69, s69, s64
    s_cmp_lg_u32 s69, 0
    s_cbranch_scc1 L_end
    v_mul_u32_u24 v24, 128, v1
    s_mov_b32 s80, 4096
    s_mov_b32 s81, 12288
    s_mov_b32 s82, 20480
    s_mov_b32 s83, 28672
    s_mov_b32 s71, 20000
L_poll_27:
    buffer_load_dword v96, v24, s[36:39], s80 offen sc1
    buffer_load_dword v97, v24, s[36:39], s81 offen sc1
    buffer_load_dword v98, v24, s[36:39], s82 offen sc1
    buffer_load_dword v99, v24, s[36:39], s83 offen sc1
    s_waitcnt vmcnt(0)
    v_xor_b32 v25, s66, v96
    v_bitop3_b32 v25, v25, v97, s66 bitop3:0xf6
    v_bitop3_b32 v25, v25, v98, s66 bitop3:0xf6
    v_bitop3_b32 v25, v25, v99, s66 bitop3:0xf6
    v_cmp_ne_u32 vcc, 0, v25
    s_nop 0
    s_cmp_eq_u64 vcc, 0
    s_cbranch_scc1 L_polld_28
    s_sub_u32 s71, s71, 1
    s_cmp_lg_u32 s71, 0
    s_cbranch_scc1 L_poll_27
L_polld_28:
    s_mov_b32 s69, 0
    s_mov_b32 exec_hi, 0
    buffer_store_dword v3, v6, s[36:39], s69 offen sc1
    s_mov_b32 exec_hi, -1
L_end:
    s_endpgm
L_codeend:
.section .rodata,"a"
.p2align 6
.amdhsa_kernel gated_mix__ssm_conv_h3__mixer_gmlp__prompt_kernel
  .amdhsa_next_free_vgpr 512
  .amdhsa_next_free_sgpr 102
  .amdhsa_accum_offset 256
  .amdhsa_group_segment_fixed_size 0
  .amdhsa_kernarg_size 120
  .amdhsa_user_sgpr_count 2
  .amdhsa_user_sgpr_kernarg_segment_ptr 1
  .amdhsa_system_sgpr_workgroup_id_x 1
.end_amdhsa_kernel
```
